```python
import torch

def _softmax(x, axis=-1):
    return torch.softmax(x, dim=axis)
def _gelu(x):
    return torch.nn.functional.gelu(x, approximate="tanh")
def _silu(x):
    return torch.nn.functional.silu(x)
def _sigmoid(x):
    return torch.sigmoid(x)
def _layernorm(x, axis=-1, eps=1e-5):
    m = x.mean(dim=axis, keepdim=True)
    v = x.var(dim=axis, keepdim=True, unbiased=False)
    return (x - m) / torch.sqrt(v + eps)
def _scatter_add(tgt, idx, src, axis=0):
    return tgt.clone().index_add_(axis, idx, src)
def _segment_sum(src, seg, n):
    out = torch.zeros((n,) + src.shape[1:], dtype=src.dtype)
    return out.index_add_(0, seg, src)
def _pad(x, pw):
    flat = tuple(v for pair in reversed(pw) for v in pair)
    return torch.nn.functional.pad(x, flat)

kernel_name = 'gated_mix__ssm_conv_h3__glu_gated_bilinear__prompt'

def setup_inputs():

    _w = (lambda a: (lambda t: t.to(torch.bfloat16) if t.is_floating_point() else t)(torch.as_tensor(a)))
    def _A_setup():
        B, S, D = 1, 2048, 512
        ks = 4
        return {
            "q": _w((lambda *s: torch.randn(*s, dtype=torch.bfloat16) * 0.05)(B, S, D)),
            "k": _w((lambda *s: torch.randn(*s, dtype=torch.bfloat16) * 0.05)(B, S, D)),
            "v": _w((lambda *s: torch.randn(*s, dtype=torch.bfloat16) * 0.05)(B, S, D)),
            "shift_k": _w((lambda *s: torch.randn(*s, dtype=torch.bfloat16) * 0.05)(D, ks) * 0.5),
            "ssm_k": _w((lambda *s: torch.randn(*s, dtype=torch.bfloat16) * 0.05)(D, S) * (1.0 / S ** 0.5)),
            "ssm_D": _w((lambda *s: torch.randn(*s, dtype=torch.bfloat16) * 0.05)(D)),
        }
    _A_in = _A_setup()

    def _B_setup():
        B, S, D, F = 1, 2048, 512, 1792
        return {
            "x": _w((lambda *s: torch.randn(*s, dtype=torch.bfloat16) * 0.05)(B, S, D)),
            "w_gate": _w((lambda *s: torch.randn(*s, dtype=torch.bfloat16) * 0.1)(D, F) * (D ** -0.5)),
            "w_up": _w((lambda *s: torch.randn(*s, dtype=torch.bfloat16) * 0.1)(D, F) * (D ** -0.5)),
            "w_down": _w((lambda *s: torch.randn(*s, dtype=torch.bfloat16) * 0.1)(F, D) * (F ** -0.5)),
        }
    _B_in = _B_setup()

    return {
        "A_q": _A_in["q"],
        "A_k": _A_in["k"],
        "A_v": _A_in["v"],
        "A_shift_k": _A_in["shift_k"],
        "A_ssm_k": _A_in["ssm_k"],
        "A_ssm_D": _A_in["ssm_D"],
        "B_x": _B_in["x"],
        "B_w_gate": _B_in["w_gate"],
        "B_w_up": _B_in["w_up"],
        "B_w_down": _B_in["w_down"],
        "gate_w": _w((lambda *s: torch.randn(*s, dtype=torch.bfloat16) * 0.05)(512) * 16.0),
    }

def reference(A_q, A_k, A_v, A_shift_k, A_ssm_k, A_ssm_D, B_x, B_w_gate, B_w_up, B_w_down, gate_w):
    def _A_ref(q, k, v, shift_k, ssm_k, ssm_D):
        B, S, D = q.shape
        ks = shift_k.shape[-1]
        k_pad = _pad(k, ((0, 0), (ks - 1, 0), (0, 0)))
        k_shift = torch.zeros_like(k)
        for t in range(ks):
            k_shift = k_shift + k_pad[:, t:t + S, :] * shift_k[:, ks - 1 - t][None, None, :]
        kv = k_shift * v
        L = 2 * S
        kv_pad = _pad(kv, ((0, 0), (0, S), (0, 0)))
        kf_pad = _pad(ssm_k, ((0, 0), (0, S)))
        kv_f = (lambda x, axes=(-2,-1): torch.fft.rfft2(x.float(), dim=axes))(kv_pad[:, None, :, :], axes=(1, 2))
        kf_f = (lambda x, axes=(-2,-1): torch.fft.rfft2(x.float(), dim=axes))(kf_pad[:, None, :], axes=(1, 2))
        kf_f = (lambda x, *d: x.permute(*d))(kf_f, 1, 2, 0)
        y_f = kv_f * kf_f[None, :, :, :]
        y = (lambda x, s, axes=(-2,-1): torch.fft.irfft2(x, s=s, dim=axes).to(torch.bfloat16))(y_f, (1, L), axes=(1, 2))[:, 0, :S, :]
        y = y + kv * ssm_D[None, None, :]
        return q * y

    def _B_ref(x, w_gate, w_up, w_down):
        g = torch.einsum("bsd,df->bsf", x, w_gate)
        u = torch.einsum("bsd,df->bsf", x, w_up)
        h = g * u
        return torch.einsum("bsf,fd->bsd", h, w_down)

    x = A_q
    g = _sigmoid((x * gate_w).sum(-1, keepdims=True))
    a = _A_ref(x, A_k, A_v, A_shift_k, A_ssm_k, A_ssm_D)
    b = _B_ref(x, B_w_gate, B_w_up, B_w_down)
    return g * a + (1 - g) * b
```

```asm
; @launch grid=(256,1,1) block=(256,1,1) lds=163840
.amdgcn_target "amdgcn-amd-amdhsa--gfx950"
.text
.globl gated_mix__ssm_conv_h3__glu_gated_bilinear__prompt_kernel
.p2align 8
.type gated_mix__ssm_conv_h3__glu_gated_bilinear__prompt_kernel,@function
gated_mix__ssm_conv_h3__glu_gated_bilinear__prompt_kernel:
    s_cmp_ge_u32 s2, 256
    s_cbranch_scc1 L_end

    s_load_dwordx16 s[80:95], s[0:1], 0
    s_load_dwordx8 s[48:55], s[0:1], 64
    s_load_dwordx4 s[96:99], s[0:1], 96
    s_memrealtime s[72:73]

    s_mov_b32 s10, 2097152
    s_mov_b32 s11, 0x20000
    s_mov_b32 s14, 2097152
    s_mov_b32 s15, 0x20000
    s_mov_b32 s18, 2097152
    s_mov_b32 s19, 0x20000
    s_mov_b32 s22, 2097152
    s_mov_b32 s23, 0x20000
    s_mov_b32 s26, 1835008
    s_mov_b32 s27, 0x20000
    s_mov_b32 s30, 1835008
    s_mov_b32 s31, 0x20000
    s_mov_b32 s34, 1835008
    s_mov_b32 s35, 0x20000
    s_mov_b32 s38, 2097152
    s_mov_b32 s39, 0x20000
    s_mov_b32 s42, 268435456
    s_mov_b32 s43, 0x20000
    s_mov_b32 s46, 256
    s_mov_b32 s47, 0x20000
    v_lshrrev_b32 v2, 6, v0
    v_and_b32 v1, 63, v0
    s_and_b32 s4, s2, 7
    v_readfirstlane_b32 s3, v2
    s_lshr_b32 s5, s2, 3
    s_lshr_b32 s6, s4, 1
    s_lshl_b32 s6, s6, 2
    s_and_b32 s56, s5, 3
    s_add_u32 s6, s6, s56
    s_and_b32 s7, s4, 1
    s_mul_i32 s7, s7, 7
    s_lshr_b32 s56, s5, 2
    s_add_u32 s7, s7, s56

    s_and_b32 s64, s3, 1
    s_lshr_b32 s65, s3, 1
    s_and_b32 s69, s5, 7
    s_lshr_b32 s70, s5, 3
    s_lshl_b32 s56, s4, 2
    s_add_u32 s70, s70, s56
    s_lshl_b32 s58, s4, 5
    s_add_u32 s58, s58, s5
    s_mov_b32 s61, 0xffff0000
    s_add_u32 s101, s69, s70
    s_and_b32 s101, s101, 0

    v_mov_b32 v9, 0
    v_lshlrev_b32 v10, 4, v1
    v_lshrrev_b32 v2, 3, v1
    v_and_b32 v3, 7, v1
    v_lshlrev_b32 v2, 10, v2
    v_lshl_add_u32 v11, v3, 4, v2
    s_lshl_b32 s56, s5, 16
    s_lshl_b32 s57, s3, 13
    s_add_u32 s56, s56, s57
    s_lshl_b32 s57, s4, 7
    s_add_u32 s56, s56, s57
    v_add_u32 v28, s56, v11
    v_add_u32 v29, 0x8000, v28
    v_subrev_u32 v30, 0x1000, v28
    v_add_u32 v31, 0x7000, v28
    s_mul_i32 s57, s3, 0x1c00
    s_sub_u32 s57, 0xf000, s57
    v_add_u32 v8, s57, v28
    v_and_b32 v2, 15, v1
    s_lshl_b32 s56, s4, 6
    s_lshl_b32 s57, s3, 4
    s_add_u32 s56, s56, s57
    v_add_lshl_u32 v6, v2, s56, 3
    s_lshl_b32 s59, s3, 10
    v_lshrrev_b32 v3, 4, v1
    v_mul_u32_u24 v3, 57344, v3
    v_lshl_add_u32 v3, v2, 4, v3
    s_lshl_b32 s56, s64, 3
    s_lshl_b32 s57, s65, 2
    s_add_u32 s56, s56, s57
    s_mul_i32 s56, s56, 3584
    s_lshl_b32 s57, s7, 8
    s_add_u32 s56, s56, s57
    v_add_u32 v20, s56, v3
    v_add_u32 v21, 3584, v20
    v_add_u32 v22, 7168, v20
    v_add_u32 v23, 10752, v20
    v_lshrrev_b32 v3, 3, v1
    v_lshlrev_b32 v3, 14, v3
    v_and_b32 v5, 7, v1
    v_lshl_add_u32 v3, v5, 4, v3
    s_lshl_b32 s56, s6, 17
    s_lshl_b32 s57, s3, 12
    s_add_u32 s56, s56, s57
    v_add_u32 v24, s56, v3
    v_add_u32 v25, 1024, v24
    v_add_u32 v26, 2048, v24
    v_add_u32 v27, 3072, v24
    s_mul_i32 s62, s3, 4224
    s_lshl_b32 s57, s58, 2
    s_waitcnt lgkmcnt(0)

    s_mov_b64 s[12:13], s[82:83]
    s_mov_b64 s[16:17], s[84:85]
    s_mov_b64 s[28:29], s[48:49]
    s_mov_b64 s[32:33], s[50:51]
    s_mov_b64 s[48:49], s[86:87]
    s_mov_b64 s[50:51], s[90:91]
    s_mov_b64 s[36:37], s[54:55]
    s_mov_b64 s[8:9], s[80:81]
    s_mov_b64 s[20:21], s[88:89]
    s_mov_b64 s[24:25], s[94:95]
    s_mov_b64 s[44:45], s[96:97]
    s_mov_b64 s[40:41], s[98:99]

    s_load_dword s60, s[50:51], s57
    s_mov_b32 s54, s72
    s_or_b32 s55, s73, 0x80000000
    s_or_b32 s56, s2, s3
    s_cmp_lg_u32 s56, 0
    s_cbranch_scc1 L_nononce
    v_mov_b32 v2, s54
    v_mov_b32 v3, s55
    s_mov_b64 exec, 1
    buffer_store_dwordx2 v[2:3], v9, s[44:47], 0 offen sc1
    s_mov_b64 exec, -1
L_nononce:

    s_cmp_ge_u32 s5, 28
    s_cbranch_scc1 L_spare

    s_lshl_b32 s56, s3, 7
    s_add_u32 m0, s56, 117760
    s_mov_b64 exec, 0xff
    buffer_load_dwordx4 v8, s[12:15], 0 offen nt lds
    s_mov_b64 exec, -1
    s_add_u32 m0, s59, 109568
    s_nop 0
    buffer_load_dwordx4 v30, s[12:15], 0 offen nt lds
    s_add_u32 m0, s59, 113664
    s_nop 0
    buffer_load_dwordx4 v31, s[12:15], 0 offen nt lds
    s_add_u32 m0, s59, 101376
    s_nop 0
    buffer_load_dwordx4 v28, s[16:19], 0 offen nt lds
    s_add_u32 m0, s59, 105472
    s_nop 0
    buffer_load_dwordx4 v29, s[16:19], 0 offen nt lds
    global_load_dwordx2 v[30:31], v6, s[48:49]
    s_barrier
    s_mov_b32 s66, 0
    s_movk_i32 s67, 0
    s_add_u32 m0, s59, 118272
    s_nop 0
    buffer_load_dwordx4 v28, s[32:35], 0 offen nt lds
    s_add_u32 m0, s59, 122368
    s_nop 0
    buffer_load_dwordx4 v29, s[32:35], 0 offen nt lds
    s_add_u32 m0, s62, 33792
    s_nop 0
    buffer_load_dwordx4 v24, s[8:11], s67 offen lds
    s_add_u32 m0, s62, 0
    s_nop 0
    buffer_load_dwordx4 v20, s[24:27], s66 offen lds
    s_add_u32 m0, s62, 16896
    s_nop 0
    buffer_load_dwordx4 v20, s[28:31], s66 offen lds
    s_add_u32 m0, s62, 34848
    s_nop 0
    buffer_load_dwordx4 v25, s[8:11], s67 offen lds
    s_add_u32 m0, s62, 1056
    s_nop 0
    buffer_load_dwordx4 v21, s[24:27], s66 offen lds
    s_add_u32 m0, s62, 17952
    s_nop 0
    buffer_load_dwordx4 v21, s[28:31], s66 offen lds
    v_bfe_u32 v3, v1, 2, 3
    v_mul_u32_u24 v3, 1056, v3
    v_lshrrev_b32 v4, 5, v1
    v_lshl_add_u32 v3, v4, 8, v3
    v_and_b32 v4, 3, v1
    v_lshl_add_u32 v3, v4, 3, v3
    s_lshl_b32 s56, s64, 7
    v_add_u32 v12, s56, v3
    v_add_u32 v13, 50688, v12
    v_add_u32 v14, 101376, v12
    v_and_b32 v3, 15, v1
    v_mul_u32_u24 v3, 1056, v3
    v_lshrrev_b32 v4, 4, v1
    v_lshl_add_u32 v3, v4, 4, v3
    s_lshl_b32 s56, s65, 9
    s_add_u32 s56, s56, 33792
    v_add_u32 v15, s56, v3
    v_add_u32 v16, 50688, v15
    v_add_u32 v17, 101376, v15
    s_lshl_b32 s56, s6, 1
    s_add_u32 s56, s56, s65
    s_lshl_b32 s57, s7, 1
    s_add_u32 s57, s57, s64
    s_lshl_b32 s68, s56, 5
    s_add_u32 s68, s68, s57
    s_lshl_b32 s68, s68, 7
    s_add_u32 s68, s68, 131072
    s_mul_i32 s56, s56, 28
    s_add_u32 s56, s56, s57
    s_lshl_b32 s72, s56, 13
    s_add_u32 s72, s72, 16777216
    s_add_u32 s73, s72, 4096

    v_lshrrev_b32 v3, 4, v1
    v_bfe_u32 v4, v1, 2, 2
    v_lshl_add_u32 v3, v3, 4, v4
    v_lshlrev_b32 v3, 7, v3
    v_and_b32 v5, 3, v1
    v_lshl_add_u32 v3, v5, 3, v3
    s_lshl_b32 s56, s3, 5
    s_add_u32 s56, s56, 101376
    v_add_u32 v7, s56, v3
    v_and_b32 v2, 15, v1
    v_mul_u32_u24 v2, 144, v2
    v_lshrrev_b32 v3, 4, v1
    v_sub_u32 v3, 3, v3
    v_lshl_add_u32 v2, v3, 5, v2
    s_add_u32 s56, s62, 135168
    v_add_u32 v2, s56, v2
    v_lshrrev_b32 v3, 3, v1
    v_mul_u32_u24 v4, 144, v3
    v_and_b32 v5, 7, v1
    v_lshl_add_u32 v4, v5, 4, v4
    v_add_u32 v4, s56, v4
    v_lshlrev_b32 v3, 12, v3
    v_lshl_add_u32 v3, v5, 4, v3
    s_lshl_b32 s56, s4, 18
    s_lshl_b32 s57, s3, 16
    s_add_u32 s56, s56, s57
    s_sub_u32 s57, 31, s5
    s_lshl_b32 s57, s57, 7
    s_add_u32 s56, s56, s57
    s_add_u32 s98, s56, 1048576
    s_add_u32 s99, s98, 0x8000
    s_lshl_b32 s74, s58, 7
    s_cmp_eq_u32 s3, 0
    s_cselect_b32 s74, s74, 268435456
    v_lshrrev_b32 v18, 2, v1
    v_lshlrev_b32 v18, 7, v18
    v_and_b32 v5, 3, v1
    v_lshl_add_u32 v18, v5, 4, v18
    s_lshl_b32 s56, s65, 12
    s_lshl_b32 s57, s64, 6
    s_add_u32 s56, s56, s57
    s_add_u32 s56, s56, 118272
    v_add_u32 v5, s56, v18
    s_mul_i32 s75, s4, 56
    s_lshl_b32 s57, s5, 1
    s_add_u32 s75, s75, s57
    s_add_u32 s75, s75, s65
    s_lshl_b32 s75, s75, 12
    s_lshl_b32 s57, s64, 11
    s_add_u32 s75, s75, s57
    s_add_u32 s75, s75, 8388608

    s_waitcnt vmcnt(8)
    s_barrier
    ds_read_b64_tr_b16 v[52:53], v7 offset:8192
    ds_read_b64_tr_b16 v[54:55], v7 offset:8704
    ds_read_b64_tr_b16 v[56:57], v7 offset:9216
    ds_read_b64_tr_b16 v[58:59], v7 offset:9728
    ds_read_b64_tr_b16 v[60:61], v7 offset:10240
    ds_read_b64_tr_b16 v[62:63], v7 offset:0
    ds_read_b64_tr_b16 v[64:65], v7 offset:512
    ds_read_b64_tr_b16 v[66:67], v7 offset:1024
    ds_read_b64_tr_b16 v[68:69], v7 offset:1536
    v_alignbit_b32 v80, v31, v31, 16
    v_alignbit_b32 v81, v30, v30, 16
    v_and_b32 v82, s61, v31
    v_bfi_b32 v83, s61, v30, v31
    v_and_b32 v84, 0xffff, v30
    s_waitcnt lgkmcnt(0)
    v_dot2_f32_bf16 v96, v52, v82, 0
    s_add_u32 m0, s62, 35904
    s_nop 0
    buffer_load_dwordx4 v26, s[8:11], s67 offen lds
    v_dot2_f32_bf16 v97, v53, v80, 0
    v_dot2_f32_bf16 v98, v53, v82, 0
    v_dot2_f32_bf16 v99, v54, v80, 0
    v_dot2_f32_bf16 v100, v54, v82, 0
    v_dot2_f32_bf16 v101, v55, v80, 0
    v_dot2_f32_bf16 v102, v55, v82, 0
    v_dot2_f32_bf16 v103, v56, v80, 0
    v_dot2_f32_bf16 v104, v56, v82, 0
    v_dot2_f32_bf16 v105, v57, v80, 0
    v_dot2_f32_bf16 v106, v57, v82, 0
    v_dot2_f32_bf16 v107, v58, v80, 0
    v_dot2_f32_bf16 v108, v58, v82, 0
    s_add_u32 m0, s62, 2112
    s_nop 0
    buffer_load_dwordx4 v22, s[24:27], s66 offen lds
    v_dot2_f32_bf16 v109, v59, v80, 0
    v_dot2_f32_bf16 v110, v59, v82, 0
    v_dot2_f32_bf16 v111, v60, v80, 0
    v_dot2_f32_bf16 v96, v53, v83, v96
    v_dot2_f32_bf16 v97, v54, v81, v97
    v_dot2_f32_bf16 v98, v54, v83, v98
    v_dot2_f32_bf16 v99, v55, v81, v99
    v_dot2_f32_bf16 v100, v55, v83, v100
    v_dot2_f32_bf16 v101, v56, v81, v101
    v_dot2_f32_bf16 v102, v56, v83, v102
    v_dot2_f32_bf16 v103, v57, v81, v103
    v_dot2_f32_bf16 v104, v57, v83, v104
    s_add_u32 m0, s62, 19008
    s_nop 0
    buffer_load_dwordx4 v22, s[28:31], s66 offen lds
    v_dot2_f32_bf16 v105, v58, v81, v105
    v_dot2_f32_bf16 v106, v58, v83, v106
    v_dot2_f32_bf16 v107, v59, v81, v107
    v_dot2_f32_bf16 v108, v59, v83, v108
    v_dot2_f32_bf16 v109, v60, v81, v109
    v_dot2_f32_bf16 v110, v60, v83, v110
    v_dot2_f32_bf16 v111, v61, v81, v111
    v_dot2_f32_bf16 v96, v54, v84, v96
    v_dot2_f32_bf16 v98, v55, v84, v98
    v_dot2_f32_bf16 v100, v56, v84, v100
    v_dot2_f32_bf16 v102, v57, v84, v102
    v_dot2_f32_bf16 v104, v58, v84, v104
    s_add_u32 m0, s62, 36960
    s_nop 0
    buffer_load_dwordx4 v27, s[8:11], s67 offen lds
    v_dot2_f32_bf16 v106, v59, v84, v106
    v_dot2_f32_bf16 v108, v60, v84, v108
    v_dot2_f32_bf16 v110, v61, v84, v110
    v_lshlrev_b32 v112, 16, v62
    v_and_b32 v113, s61, v62
    v_lshlrev_b32 v114, 16, v63
    v_and_b32 v115, s61, v63
    v_lshlrev_b32 v116, 16, v64
    v_and_b32 v117, s61, v64
    v_lshlrev_b32 v118, 16, v65
    v_and_b32 v119, s61, v65
    v_lshlrev_b32 v120, 16, v66
    s_add_u32 m0, s62, 3168
    s_nop 0
    buffer_load_dwordx4 v23, s[24:27], s66 offen lds
    v_and_b32 v121, s61, v66
    v_lshlrev_b32 v122, 16, v67
    v_and_b32 v123, s61, v67
    v_lshlrev_b32 v124, 16, v68
    v_and_b32 v125, s61, v68
    v_lshlrev_b32 v126, 16, v69
    v_and_b32 v127, s61, v69
    v_pk_mul_f32 v[96:97], v[96:97], v[112:113]
    v_pk_mul_f32 v[98:99], v[98:99], v[114:115]
    v_pk_mul_f32 v[100:101], v[100:101], v[116:117]
    v_pk_mul_f32 v[102:103], v[102:103], v[118:119]
    v_pk_mul_f32 v[104:105], v[104:105], v[120:121]
    s_add_u32 m0, s62, 20064
    s_nop 0
    buffer_load_dwordx4 v23, s[28:31], s66 offen lds
    v_pk_mul_f32 v[106:107], v[106:107], v[122:123]
    v_pk_mul_f32 v[108:109], v[108:109], v[124:125]
    v_pk_mul_f32 v[110:111], v[110:111], v[126:127]
    v_cvt_pk_bf16_f32 v112, v111, v110
    v_cvt_pk_bf16_f32 v113, v109, v108
    v_cvt_pk_bf16_f32 v114, v107, v106
    v_cvt_pk_bf16_f32 v115, v105, v104
    v_cvt_pk_bf16_f32 v116, v103, v102
    v_cvt_pk_bf16_f32 v117, v101, v100
    v_cvt_pk_bf16_f32 v118, v99, v98
    v_cvt_pk_bf16_f32 v119, v97, v96
    ds_write_b128 v2, v[112:115]
    ds_write_b128 v2, v[116:119] offset:16
    ds_read_b128 a[232:235], v4
    ds_read_b128 a[236:239], v4 offset:1152
    s_waitcnt vmcnt(12)
    s_barrier
    ds_read_b64_tr_b16 a[240:241], v5
    ds_read_b64_tr_b16 a[242:243], v5 offset:2048
    ds_read_b64_tr_b16 a[244:245], v5 offset:8
    ds_read_b64_tr_b16 a[246:247], v5 offset:2056
    s_mov_b32 s66, 229376
    s_movk_i32 s67, 128
    s_add_u32 m0, s62, 84480
    s_nop 0
    buffer_load_dwordx4 v24, s[8:11], s67 offen lds
    s_add_u32 m0, s62, 50688
    s_nop 0
    buffer_load_dwordx4 v20, s[24:27], s66 offen lds
    s_add_u32 m0, s62, 67584
    s_nop 0
    buffer_load_dwordx4 v20, s[28:31], s66 offen lds
    s_add_u32 m0, s62, 85536
    s_nop 0
    buffer_load_dwordx4 v25, s[8:11], s67 offen lds
    s_add_u32 m0, s62, 51744
    s_nop 0
    buffer_load_dwordx4 v21, s[24:27], s66 offen lds
    s_add_u32 m0, s62, 68640
    s_nop 0
    buffer_load_dwordx4 v21, s[28:31], s66 offen lds
    s_add_u32 m0, s62, 86592
    s_nop 0
    buffer_load_dwordx4 v26, s[8:11], s67 offen lds
    s_add_u32 m0, s62, 52800
    s_nop 0
    buffer_load_dwordx4 v22, s[24:27], s66 offen lds
    s_add_u32 m0, s62, 69696
    s_nop 0
    buffer_load_dwordx4 v22, s[28:31], s66 offen lds
    s_add_u32 m0, s62, 87648
    s_nop 0
    buffer_load_dwordx4 v27, s[8:11], s67 offen lds
    s_add_u32 m0, s62, 53856
    s_nop 0
    buffer_load_dwordx4 v23, s[24:27], s66 offen lds
    s_add_u32 m0, s62, 70752
    s_nop 0
    buffer_load_dwordx4 v23, s[28:31], s66 offen lds
    s_lshl_b32 s56, s58, 13
    s_add_u32 s56, s56, s59
    s_add_u32 m0, s59, 152576
    s_nop 0
    buffer_load_dwordx4 v10, s[20:23], s56 offen nt lds
    s_add_u32 s56, s56, 4096
    s_add_u32 m0, s59, 157184
    s_nop 0
    buffer_load_dwordx4 v10, s[20:23], s56 offen nt lds
    s_waitcnt lgkmcnt(0)
    s_waitcnt vmcnt(14)
    s_barrier
    ds_read_b64_tr_b16 v[32:33], v12 offset:0
    ds_read_b64_tr_b16 v[34:35], v12 offset:8448
    ds_read_b128 v[64:67], v15 offset:0
    ds_read_b128 v[68:71], v15 offset:128
    ds_read_b128 v[72:75], v15 offset:256
    ds_read_b128 v[76:79], v15 offset:384
    ds_read_b64_tr_b16 v[48:49], v12 offset:16896
    ds_read_b64_tr_b16 v[50:51], v12 offset:25344
    ds_read_b64_tr_b16 v[36:37], v12 offset:32
    ds_read_b64_tr_b16 v[38:39], v12 offset:8480
    ds_read_b64_tr_b16 v[52:53], v12 offset:16928
    ds_read_b64_tr_b16 v[54:55], v12 offset:25376
    ds_read_b64_tr_b16 v[40:41], v12 offset:64
    ds_read_b64_tr_b16 v[42:43], v12 offset:8512
    ds_read_b64_tr_b16 v[56:57], v12 offset:16960
    ds_read_b64_tr_b16 v[58:59], v12 offset:25408
    ds_read_b64_tr_b16 v[44:45], v12 offset:96
    ds_read_b64_tr_b16 v[46:47], v12 offset:8544
    ds_read_b64_tr_b16 v[60:61], v12 offset:16992
    ds_read_b64_tr_b16 v[62:63], v12 offset:25440
    s_waitcnt lgkmcnt(0)
    v_mfma_f32_16x16x32_bf16 v[128:131], v[32:35], v[64:67], 0
    ds_read_b64_tr_b16 v[80:81], v12 offset:512
    v_mfma_f32_16x16x32_bf16 v[132:135], v[32:35], v[68:71], 0
    ds_read_b64_tr_b16 v[82:83], v12 offset:8960
    v_mfma_f32_16x16x32_bf16 v[136:139], v[32:35], v[72:75], 0
    ds_read_b128 v[112:115], v15 offset:64
    s_mov_b32 s66, 458752
    s_movk_i32 s67, 256
    s_add_u32 m0, s62, 135168
    v_mfma_f32_16x16x32_bf16 v[140:143], v[32:35], v[76:79], 0
    buffer_load_dwordx4 v24, s[8:11], s67 offen lds
    ds_read_b128 v[116:119], v15 offset:192
    v_mfma_f32_16x16x32_bf16 v[192:195], v[48:51], v[64:67], 0
    ds_read_b128 v[120:123], v15 offset:320
    v_mfma_f32_16x16x32_bf16 v[196:199], v[48:51], v[68:71], 0
    ds_read_b128 v[124:127], v15 offset:448
    v_mfma_f32_16x16x32_bf16 v[200:203], v[48:51], v[72:75], 0
    ds_read_b64_tr_b16 v[96:97], v12 offset:17408
    s_add_u32 m0, s62, 101376
    v_mfma_f32_16x16x32_bf16 v[204:207], v[48:51], v[76:79], 0
    buffer_load_dwordx4 v20, s[24:27], s66 offen lds
    ds_read_b64_tr_b16 v[98:99], v12 offset:25856
    v_mfma_f32_16x16x32_bf16 v[144:147], v[36:39], v[64:67], 0
    ds_read_b64_tr_b16 v[84:85], v12 offset:544
    v_mfma_f32_16x16x32_bf16 v[148:151], v[36:39], v[68:71], 0
    ds_read_b64_tr_b16 v[86:87], v12 offset:8992
    v_mfma_f32_16x16x32_bf16 v[152:155], v[36:39], v[72:75], 0
    ds_read_b64_tr_b16 v[100:101], v12 offset:17440
    v_mfma_f32_16x16x32_bf16 v[156:159], v[36:39], v[76:79], 0
    ds_read_b64_tr_b16 v[102:103], v12 offset:25888
    s_add_u32 m0, s62, 118272
    v_mfma_f32_16x16x32_bf16 v[208:211], v[52:55], v[64:67], 0
    buffer_load_dwordx4 v20, s[28:31], s66 offen lds
    ds_read_b64_tr_b16 v[88:89], v12 offset:576
    v_mfma_f32_16x16x32_bf16 v[212:215], v[52:55], v[68:71], 0
    ds_read_b64_tr_b16 v[90:91], v12 offset:9024
    v_mfma_f32_16x16x32_bf16 v[216:219], v[52:55], v[72:75], 0
    ds_read_b64_tr_b16 v[104:105], v12 offset:17472
    v_mfma_f32_16x16x32_bf16 v[220:223], v[52:55], v[76:79], 0
    ds_read_b64_tr_b16 v[106:107], v12 offset:25920
    s_add_u32 m0, s62, 136224
    v_mfma_f32_16x16x32_bf16 v[160:163], v[40:43], v[64:67], 0
    buffer_load_dwordx4 v25, s[8:11], s67 offen lds
    ds_read_b64_tr_b16 v[92:93], v12 offset:608
    v_mfma_f32_16x16x32_bf16 v[164:167], v[40:43], v[68:71], 0
    ds_read_b64_tr_b16 v[94:95], v12 offset:9056
    v_mfma_f32_16x16x32_bf16 v[168:171], v[40:43], v[72:75], 0
    ds_read_b64_tr_b16 v[108:109], v12 offset:17504
    v_mfma_f32_16x16x32_bf16 v[172:175], v[40:43], v[76:79], 0
    ds_read_b64_tr_b16 v[110:111], v12 offset:25952
    v_mfma_f32_16x16x32_bf16 v[224:227], v[56:59], v[64:67], 0
    s_add_u32 m0, s62, 102432
    v_mfma_f32_16x16x32_bf16 v[228:231], v[56:59], v[68:71], 0
    buffer_load_dwordx4 v21, s[24:27], s66 offen lds
    v_mfma_f32_16x16x32_bf16 v[232:235], v[56:59], v[72:75], 0
    v_mfma_f32_16x16x32_bf16 v[236:239], v[56:59], v[76:79], 0
    v_mfma_f32_16x16x32_bf16 v[176:179], v[44:47], v[64:67], 0
    s_add_u32 m0, s62, 119328
    v_mfma_f32_16x16x32_bf16 v[180:183], v[44:47], v[68:71], 0
    buffer_load_dwordx4 v21, s[28:31], s66 offen lds
    v_mfma_f32_16x16x32_bf16 v[184:187], v[44:47], v[72:75], 0
    v_mfma_f32_16x16x32_bf16 v[188:191], v[44:47], v[76:79], 0
    v_mfma_f32_16x16x32_bf16 v[240:243], v[60:63], v[64:67], 0
    v_mfma_f32_16x16x32_bf16 v[244:247], v[60:63], v[68:71], 0
    v_mfma_f32_16x16x32_bf16 v[248:251], v[60:63], v[72:75], 0
    v_mfma_f32_16x16x32_bf16 v[252:255], v[60:63], v[76:79], 0
    s_waitcnt lgkmcnt(0)
    v_mfma_f32_16x16x32_bf16 v[128:131], v[80:83], v[112:115], v[128:131]
    v_mfma_f32_16x16x32_bf16 v[132:135], v[80:83], v[116:119], v[132:135]
    v_mfma_f32_16x16x32_bf16 v[136:139], v[80:83], v[120:123], v[136:139]
    v_mfma_f32_16x16x32_bf16 v[140:143], v[80:83], v[124:127], v[140:143]
    v_mfma_f32_16x16x32_bf16 v[192:195], v[96:99], v[112:115], v[192:195]
    v_mfma_f32_16x16x32_bf16 v[196:199], v[96:99], v[116:119], v[196:199]
    v_mfma_f32_16x16x32_bf16 v[200:203], v[96:99], v[120:123], v[200:203]
    v_mfma_f32_16x16x32_bf16 v[204:207], v[96:99], v[124:127], v[204:207]
    s_waitcnt vmcnt(8)
    s_barrier
    v_mfma_f32_16x16x32_bf16 v[144:147], v[84:87], v[112:115], v[144:147]
    ds_read_b64_tr_b16 v[32:33], v13 offset:0
    ds_read_b64_tr_b16 v[34:35], v13 offset:8448
    v_mfma_f32_16x16x32_bf16 v[148:151], v[84:87], v[116:119], v[148:151]
    ds_read_b128 v[64:67], v16 offset:0
    v_mfma_f32_16x16x32_bf16 v[152:155], v[84:87], v[120:123], v[152:155]
    ds_read_b128 v[68:71], v16 offset:128
    s_add_u32 m0, s62, 137280
    v_mfma_f32_16x16x32_bf16 v[156:159], v[84:87], v[124:127], v[156:159]
    buffer_load_dwordx4 v26, s[8:11], s67 offen lds
    ds_read_b128 v[72:75], v16 offset:256
    v_mfma_f32_16x16x32_bf16 v[208:211], v[100:103], v[112:115], v[208:211]
    ds_read_b128 v[76:79], v16 offset:384
    ds_read_b64_tr_b16 v[48:49], v13 offset:16896
    v_mfma_f32_16x16x32_bf16 v[212:215], v[100:103], v[116:119], v[212:215]
    ds_read_b64_tr_b16 v[50:51], v13 offset:25344
    s_add_u32 m0, s62, 103488
    v_mfma_f32_16x16x32_bf16 v[216:219], v[100:103], v[120:123], v[216:219]
    buffer_load_dwordx4 v22, s[24:27], s66 offen lds
    ds_read_b64_tr_b16 v[36:37], v13 offset:32
    v_mfma_f32_16x16x32_bf16 v[220:223], v[100:103], v[124:127], v[220:223]
    ds_read_b64_tr_b16 v[38:39], v13 offset:8480
    v_mfma_f32_16x16x32_bf16 v[160:163], v[88:91], v[112:115], v[160:163]
    ds_read_b64_tr_b16 v[52:53], v13 offset:16928
    ds_read_b64_tr_b16 v[54:55], v13 offset:25376
    s_add_u32 m0, s62, 120384
    v_mfma_f32_16x16x32_bf16 v[164:167], v[88:91], v[116:119], v[164:167]
    buffer_load_dwordx4 v22, s[28:31], s66 offen lds
    ds_read_b64_tr_b16 v[40:41], v13 offset:64
    v_mfma_f32_16x16x32_bf16 v[168:171], v[88:91], v[120:123], v[168:171]
    ds_read_b64_tr_b16 v[42:43], v13 offset:8512
    v_mfma_f32_16x16x32_bf16 v[172:175], v[88:91], v[124:127], v[172:175]
    ds_read_b64_tr_b16 v[56:57], v13 offset:16960
    s_add_u32 m0, s62, 138336
    v_mfma_f32_16x16x32_bf16 v[224:227], v[104:107], v[112:115], v[224:227]
    buffer_load_dwordx4 v27, s[8:11], s67 offen lds
    ds_read_b64_tr_b16 v[58:59], v13 offset:25408
    ds_read_b64_tr_b16 v[44:45], v13 offset:96
    v_mfma_f32_16x16x32_bf16 v[228:231], v[104:107], v[116:119], v[228:231]
    ds_read_b64_tr_b16 v[46:47], v13 offset:8544
    v_mfma_f32_16x16x32_bf16 v[232:235], v[104:107], v[120:123], v[232:235]
    ds_read_b64_tr_b16 v[60:61], v13 offset:16992
    s_add_u32 m0, s62, 104544
    v_mfma_f32_16x16x32_bf16 v[236:239], v[104:107], v[124:127], v[236:239]
    buffer_load_dwordx4 v23, s[24:27], s66 offen lds
    ds_read_b64_tr_b16 v[62:63], v13 offset:25440
    v_mfma_f32_16x16x32_bf16 v[176:179], v[92:95], v[112:115], v[176:179]
    v_mfma_f32_16x16x32_bf16 v[180:183], v[92:95], v[116:119], v[180:183]
    s_add_u32 m0, s62, 121440
    v_mfma_f32_16x16x32_bf16 v[184:187], v[92:95], v[120:123], v[184:187]
    buffer_load_dwordx4 v23, s[28:31], s66 offen lds
    v_mfma_f32_16x16x32_bf16 v[188:191], v[92:95], v[124:127], v[188:191]
    v_mfma_f32_16x16x32_bf16 v[240:243], v[108:111], v[112:115], v[240:243]
    v_mfma_f32_16x16x32_bf16 v[244:247], v[108:111], v[116:119], v[244:247]
    v_mfma_f32_16x16x32_bf16 v[248:251], v[108:111], v[120:123], v[248:251]
    v_mfma_f32_16x16x32_bf16 v[252:255], v[108:111], v[124:127], v[252:255]
    buffer_store_dwordx4 a[240:243], v10, s[40:43], s75 offen sc1
    buffer_store_dwordx4 a[244:247], v10, s[40:43], s75 offen offset:1024 sc1
    buffer_store_dwordx4 a[232:235], v3, s[40:43], s98 offen sc1
    buffer_store_dwordx4 a[236:239], v3, s[40:43], s99 offen sc1
    buffer_load_dwordx2 v[18:19], v9, s[44:47], 0 offen sc1
    s_waitcnt lgkmcnt(0)
    v_mfma_f32_16x16x32_bf16 v[128:131], v[32:35], v[64:67], v[128:131]
    ds_read_b64_tr_b16 v[80:81], v13 offset:512
    v_mfma_f32_16x16x32_bf16 v[132:135], v[32:35], v[68:71], v[132:135]
    ds_read_b64_tr_b16 v[82:83], v13 offset:8960
    v_mfma_f32_16x16x32_bf16 v[136:139], v[32:35], v[72:75], v[136:139]
    ds_read_b128 v[112:115], v16 offset:64
    s_mov_b32 s66, 688128
    s_movk_i32 s67, 384
    s_add_u32 m0, s62, 33792
    v_mfma_f32_16x16x32_bf16 v[140:143], v[32:35], v[76:79], v[140:143]
    buffer_load_dwordx4 v24, s[8:11], s67 offen lds
    ds_read_b128 v[116:119], v16 offset:192
    v_mfma_f32_16x16x32_bf16 v[192:195], v[48:51], v[64:67], v[192:195]
    ds_read_b128 v[120:123], v16 offset:320
    v_mfma_f32_16x16x32_bf16 v[196:199], v[48:51], v[68:71], v[196:199]
    ds_read_b128 v[124:127], v16 offset:448
    v_mfma_f32_16x16x32_bf16 v[200:203], v[48:51], v[72:75], v[200:203]
    ds_read_b64_tr_b16 v[96:97], v13 offset:17408
    s_add_u32 m0, s62, 0
    v_mfma_f32_16x16x32_bf16 v[204:207], v[48:51], v[76:79], v[204:207]
    buffer_load_dwordx4 v20, s[24:27], s66 offen lds
    ds_read_b64_tr_b16 v[98:99], v13 offset:25856
    v_mfma_f32_16x16x32_bf16 v[144:147], v[36:39], v[64:67], v[144:147]
    ds_read_b64_tr_b16 v[84:85], v13 offset:544
    v_mfma_f32_16x16x32_bf16 v[148:151], v[36:39], v[68:71], v[148:151]
    ds_read_b64_tr_b16 v[86:87], v13 offset:8992
    v_mfma_f32_16x16x32_bf16 v[152:155], v[36:39], v[72:75], v[152:155]
    ds_read_b64_tr_b16 v[100:101], v13 offset:17440
    v_mfma_f32_16x16x32_bf16 v[156:159], v[36:39], v[76:79], v[156:159]
    ds_read_b64_tr_b16 v[102:103], v13 offset:25888
    s_add_u32 m0, s62, 16896
    v_mfma_f32_16x16x32_bf16 v[208:211], v[52:55], v[64:67], v[208:211]
    buffer_load_dwordx4 v20, s[28:31], s66 offen lds
    ds_read_b64_tr_b16 v[88:89], v13 offset:576
    v_mfma_f32_16x16x32_bf16 v[212:215], v[52:55], v[68:71], v[212:215]
    ds_read_b64_tr_b16 v[90:91], v13 offset:9024
    v_mfma_f32_16x16x32_bf16 v[216:219], v[52:55], v[72:75], v[216:219]
    ds_read_b64_tr_b16 v[104:105], v13 offset:17472
    v_mfma_f32_16x16x32_bf16 v[220:223], v[52:55], v[76:79], v[220:223]
    ds_read_b64_tr_b16 v[106:107], v13 offset:25920
    s_add_u32 m0, s62, 34848
    v_mfma_f32_16x16x32_bf16 v[160:163], v[40:43], v[64:67], v[160:163]
    buffer_load_dwordx4 v25, s[8:11], s67 offen lds
    ds_read_b64_tr_b16 v[92:93], v13 offset:608
    v_mfma_f32_16x16x32_bf16 v[164:167], v[40:43], v[68:71], v[164:167]
    ds_read_b64_tr_b16 v[94:95], v13 offset:9056
    v_mfma_f32_16x16x32_bf16 v[168:171], v[40:43], v[72:75], v[168:171]
    ds_read_b64_tr_b16 v[108:109], v13 offset:17504
    v_mfma_f32_16x16x32_bf16 v[172:175], v[40:43], v[76:79], v[172:175]
    ds_read_b64_tr_b16 v[110:111], v13 offset:25952
    v_mfma_f32_16x16x32_bf16 v[224:227], v[56:59], v[64:67], v[224:227]
    s_add_u32 m0, s62, 1056
    v_mfma_f32_16x16x32_bf16 v[228:231], v[56:59], v[68:71], v[228:231]
    buffer_load_dwordx4 v21, s[24:27], s66 offen lds
    v_mfma_f32_16x16x32_bf16 v[232:235], v[56:59], v[72:75], v[232:235]
    v_mfma_f32_16x16x32_bf16 v[236:239], v[56:59], v[76:79], v[236:239]
    v_mfma_f32_16x16x32_bf16 v[176:179], v[44:47], v[64:67], v[176:179]
    s_add_u32 m0, s62, 17952
    v_mfma_f32_16x16x32_bf16 v[180:183], v[44:47], v[68:71], v[180:183]
    buffer_load_dwordx4 v21, s[28:31], s66 offen lds
    v_mfma_f32_16x16x32_bf16 v[184:187], v[44:47], v[72:75], v[184:187]
    v_mfma_f32_16x16x32_bf16 v[188:191], v[44:47], v[76:79], v[188:191]
    v_mfma_f32_16x16x32_bf16 v[240:243], v[60:63], v[64:67], v[240:243]
    v_mfma_f32_16x16x32_bf16 v[244:247], v[60:63], v[68:71], v[244:247]
    v_mfma_f32_16x16x32_bf16 v[248:251], v[60:63], v[72:75], v[248:251]
    v_mfma_f32_16x16x32_bf16 v[252:255], v[60:63], v[76:79], v[252:255]
    s_waitcnt lgkmcnt(0)
    v_mfma_f32_16x16x32_bf16 v[128:131], v[80:83], v[112:115], v[128:131]
    v_mfma_f32_16x16x32_bf16 v[132:135], v[80:83], v[116:119], v[132:135]
    v_mfma_f32_16x16x32_bf16 v[136:139], v[80:83], v[120:123], v[136:139]
    v_mfma_f32_16x16x32_bf16 v[140:143], v[80:83], v[124:127], v[140:143]
    v_mfma_f32_16x16x32_bf16 v[192:195], v[96:99], v[112:115], v[192:195]
    v_mfma_f32_16x16x32_bf16 v[196:199], v[96:99], v[116:119], v[196:199]
    v_mfma_f32_16x16x32_bf16 v[200:203], v[96:99], v[120:123], v[200:203]
    v_mfma_f32_16x16x32_bf16 v[204:207], v[96:99], v[124:127], v[204:207]
    s_waitcnt vmcnt(11)
    s_barrier
    v_mfma_f32_16x16x32_bf16 v[144:147], v[84:87], v[112:115], v[144:147]
    ds_read_b64_tr_b16 v[32:33], v14 offset:0
    ds_read_b64_tr_b16 v[34:35], v14 offset:8448
    v_mfma_f32_16x16x32_bf16 v[148:151], v[84:87], v[116:119], v[148:151]
    ds_read_b128 v[64:67], v17 offset:0
    v_mfma_f32_16x16x32_bf16 v[152:155], v[84:87], v[120:123], v[152:155]
    ds_read_b128 v[68:71], v17 offset:128
    s_add_u32 m0, s62, 35904
    v_mfma_f32_16x16x32_bf16 v[156:159], v[84:87], v[124:127], v[156:159]
    buffer_load_dwordx4 v26, s[8:11], s67 offen lds
    ds_read_b128 v[72:75], v17 offset:256
    v_mfma_f32_16x16x32_bf16 v[208:211], v[100:103], v[112:115], v[208:211]
    ds_read_b128 v[76:79], v17 offset:384
    ds_read_b64_tr_b16 v[48:49], v14 offset:16896
    v_mfma_f32_16x16x32_bf16 v[212:215], v[100:103], v[116:119], v[212:215]
    ds_read_b64_tr_b16 v[50:51], v14 offset:25344
    s_add_u32 m0, s62, 2112
    v_mfma_f32_16x16x32_bf16 v[216:219], v[100:103], v[120:123], v[216:219]
    buffer_load_dwordx4 v22, s[24:27], s66 offen lds
    ds_read_b64_tr_b16 v[36:37], v14 offset:32
    v_mfma_f32_16x16x32_bf16 v[220:223], v[100:103], v[124:127], v[220:223]
    ds_read_b64_tr_b16 v[38:39], v14 offset:8480
    v_mfma_f32_16x16x32_bf16 v[160:163], v[88:91], v[112:115], v[160:163]
    ds_read_b64_tr_b16 v[52:53], v14 offset:16928
    ds_read_b64_tr_b16 v[54:55], v14 offset:25376
    s_add_u32 m0, s62, 19008
    v_mfma_f32_16x16x32_bf16 v[164:167], v[88:91], v[116:119], v[164:167]
    buffer_load_dwordx4 v22, s[28:31], s66 offen lds
    ds_read_b64_tr_b16 v[40:41], v14 offset:64
    v_mfma_f32_16x16x32_bf16 v[168:171], v[88:91], v[120:123], v[168:171]
    ds_read_b64_tr_b16 v[42:43], v14 offset:8512
    v_mfma_f32_16x16x32_bf16 v[172:175], v[88:91], v[124:127], v[172:175]
    ds_read_b64_tr_b16 v[56:57], v14 offset:16960
    s_add_u32 m0, s62, 36960
    v_mfma_f32_16x16x32_bf16 v[224:227], v[104:107], v[112:115], v[224:227]
    buffer_load_dwordx4 v27, s[8:11], s67 offen lds
    ds_read_b64_tr_b16 v[58:59], v14 offset:25408
    ds_read_b64_tr_b16 v[44:45], v14 offset:96
    v_mfma_f32_16x16x32_bf16 v[228:231], v[104:107], v[116:119], v[228:231]
    ds_read_b64_tr_b16 v[46:47], v14 offset:8544
    v_mfma_f32_16x16x32_bf16 v[232:235], v[104:107], v[120:123], v[232:235]
    ds_read_b64_tr_b16 v[60:61], v14 offset:16992
    s_add_u32 m0, s62, 3168
    v_mfma_f32_16x16x32_bf16 v[236:239], v[104:107], v[124:127], v[236:239]
    buffer_load_dwordx4 v23, s[24:27], s66 offen lds
    ds_read_b64_tr_b16 v[62:63], v14 offset:25440
    v_mfma_f32_16x16x32_bf16 v[176:179], v[92:95], v[112:115], v[176:179]
    v_mfma_f32_16x16x32_bf16 v[180:183], v[92:95], v[116:119], v[180:183]
    s_add_u32 m0, s62, 20064
    v_mfma_f32_16x16x32_bf16 v[184:187], v[92:95], v[120:123], v[184:187]
    buffer_load_dwordx4 v23, s[28:31], s66 offen lds
    v_mfma_f32_16x16x32_bf16 v[188:191], v[92:95], v[124:127], v[188:191]
    v_mfma_f32_16x16x32_bf16 v[240:243], v[108:111], v[112:115], v[240:243]
    v_mfma_f32_16x16x32_bf16 v[244:247], v[108:111], v[116:119], v[244:247]
    v_mfma_f32_16x16x32_bf16 v[248:251], v[108:111], v[120:123], v[248:251]
    v_mfma_f32_16x16x32_bf16 v[252:255], v[108:111], v[124:127], v[252:255]
    s_waitcnt lgkmcnt(0)
    v_mfma_f32_16x16x32_bf16 v[128:131], v[32:35], v[64:67], v[128:131]
    ds_read_b64_tr_b16 v[80:81], v14 offset:512
    v_mfma_f32_16x16x32_bf16 v[132:135], v[32:35], v[68:71], v[132:135]
    ds_read_b64_tr_b16 v[82:83], v14 offset:8960
    v_mfma_f32_16x16x32_bf16 v[136:139], v[32:35], v[72:75], v[136:139]
    ds_read_b128 v[112:115], v17 offset:64
    s_mov_b32 s66, 917504
    s_movk_i32 s67, 512
    s_add_u32 m0, s62, 84480
    v_mfma_f32_16x16x32_bf16 v[140:143], v[32:35], v[76:79], v[140:143]
    buffer_load_dwordx4 v24, s[8:11], s67 offen lds
    ds_read_b128 v[116:119], v17 offset:192
    v_mfma_f32_16x16x32_bf16 v[192:195], v[48:51], v[64:67], v[192:195]
    ds_read_b128 v[120:123], v17 offset:320
    v_mfma_f32_16x16x32_bf16 v[196:199], v[48:51], v[68:71], v[196:199]
    ds_read_b128 v[124:127], v17 offset:448
    v_mfma_f32_16x16x32_bf16 v[200:203], v[48:51], v[72:75], v[200:203]
    ds_read_b64_tr_b16 v[96:97], v14 offset:17408
    s_add_u32 m0, s62, 50688
    v_mfma_f32_16x16x32_bf16 v[204:207], v[48:51], v[76:79], v[204:207]
    buffer_load_dwordx4 v20, s[24:27], s66 offen lds
    ds_read_b64_tr_b16 v[98:99], v14 offset:25856
    v_mfma_f32_16x16x32_bf16 v[144:147], v[36:39], v[64:67], v[144:147]
    ds_read_b64_tr_b16 v[84:85], v14 offset:544
    v_mfma_f32_16x16x32_bf16 v[148:151], v[36:39], v[68:71], v[148:151]
    ds_read_b64_tr_b16 v[86:87], v14 offset:8992
    v_mfma_f32_16x16x32_bf16 v[152:155], v[36:39], v[72:75], v[152:155]
    ds_read_b64_tr_b16 v[100:101], v14 offset:17440
    v_mfma_f32_16x16x32_bf16 v[156:159], v[36:39], v[76:79], v[156:159]
    ds_read_b64_tr_b16 v[102:103], v14 offset:25888
    s_add_u32 m0, s62, 67584
    v_mfma_f32_16x16x32_bf16 v[208:211], v[52:55], v[64:67], v[208:211]
    buffer_load_dwordx4 v20, s[28:31], s66 offen lds
    ds_read_b64_tr_b16 v[88:89], v14 offset:576
    v_mfma_f32_16x16x32_bf16 v[212:215], v[52:55], v[68:71], v[212:215]
    ds_read_b64_tr_b16 v[90:91], v14 offset:9024
    v_mfma_f32_16x16x32_bf16 v[216:219], v[52:55], v[72:75], v[216:219]
    ds_read_b64_tr_b16 v[104:105], v14 offset:17472
    v_mfma_f32_16x16x32_bf16 v[220:223], v[52:55], v[76:79], v[220:223]
    ds_read_b64_tr_b16 v[106:107], v14 offset:25920
    s_add_u32 m0, s62, 85536
    v_mfma_f32_16x16x32_bf16 v[160:163], v[40:43], v[64:67], v[160:163]
    buffer_load_dwordx4 v25, s[8:11], s67 offen lds
    ds_read_b64_tr_b16 v[92:93], v14 offset:608
    v_mfma_f32_16x16x32_bf16 v[164:167], v[40:43], v[68:71], v[164:167]
    ds_read_b64_tr_b16 v[94:95], v14 offset:9056
    v_mfma_f32_16x16x32_bf16 v[168:171], v[40:43], v[72:75], v[168:171]
    ds_read_b64_tr_b16 v[108:109], v14 offset:17504
    v_mfma_f32_16x16x32_bf16 v[172:175], v[40:43], v[76:79], v[172:175]
    ds_read_b64_tr_b16 v[110:111], v14 offset:25952
    v_mfma_f32_16x16x32_bf16 v[224:227], v[56:59], v[64:67], v[224:227]
    s_add_u32 m0, s62, 51744
    v_mov_b32 v4, 0
    v_mfma_f32_16x16x32_bf16 v[228:231], v[56:59], v[68:71], v[228:231]
    buffer_load_dwordx4 v21, s[24:27], s66 offen lds
    v_mov_b32 v5, 0
    v_mfma_f32_16x16x32_bf16 v[232:235], v[56:59], v[72:75], v[232:235]
    v_mov_b32 v6, 0
    v_mfma_f32_16x16x32_bf16 v[236:239], v[56:59], v[76:79], v[236:239]
    v_mov_b32 v7, 0
    v_mfma_f32_16x16x32_bf16 v[176:179], v[44:47], v[64:67], v[176:179]
    s_add_u32 m0, s62, 68640
    v_lshrrev_b32 v3, 5, v1
    v_mfma_f32_16x16x32_bf16 v[180:183], v[44:47], v[68:71], v[180:183]
    buffer_load_dwordx4 v21, s[28:31], s66 offen lds
    v_mfma_f32_16x16x32_bf16 v[184:187], v[44:47], v[72:75], v[184:187]
    v_mul_u32_u24 v3, 4608, v3
    v_mfma_f32_16x16x32_bf16 v[188:191], v[44:47], v[76:79], v[188:191]
    v_and_b32 v2, 31, v1
    v_mfma_f32_16x16x32_bf16 v[240:243], v[60:63], v[64:67], v[240:243]
    v_lshl_add_u32 v3, v2, 4, v3
    v_mfma_f32_16x16x32_bf16 v[244:247], v[60:63], v[68:71], v[244:247]
    v_add_u32 v3, 152064, v3
    v_mfma_f32_16x16x32_bf16 v[248:251], v[60:63], v[72:75], v[248:251]
    ds_write_b128 v3, v[4:7]
    v_mfma_f32_16x16x32_bf16 v[252:255], v[60:63], v[76:79], v[252:255]
    s_waitcnt lgkmcnt(0)
    v_mfma_f32_16x16x32_bf16 v[128:131], v[80:83], v[112:115], v[128:131]
    v_mfma_f32_16x16x32_bf16 v[132:135], v[80:83], v[116:119], v[132:135]
    v_mfma_f32_16x16x32_bf16 v[136:139], v[80:83], v[120:123], v[136:139]
    v_mfma_f32_16x16x32_bf16 v[140:143], v[80:83], v[124:127], v[140:143]
    v_mfma_f32_16x16x32_bf16 v[192:195], v[96:99], v[112:115], v[192:195]
    v_mfma_f32_16x16x32_bf16 v[196:199], v[96:99], v[116:119], v[196:199]
    v_mfma_f32_16x16x32_bf16 v[200:203], v[96:99], v[120:123], v[200:203]
    v_mfma_f32_16x16x32_bf16 v[204:207], v[96:99], v[124:127], v[204:207]
    s_waitcnt vmcnt(6)
    s_barrier
    v_mfma_f32_16x16x32_bf16 v[144:147], v[84:87], v[112:115], v[144:147]
    ds_read_b64_tr_b16 v[32:33], v12 offset:0
    ds_read_b64_tr_b16 v[34:35], v12 offset:8448
    s_mov_b32 s56, 0
L_nl_nn_1:
    v_readfirstlane_b32 s55, v19
    v_readfirstlane_b32 s54, v18
    s_cmp_lg_u32 s55, 0
    s_cbranch_scc1 L_nok_nn_1
    s_add_u32 s56, s56, 1
    s_cmp_lt_u32 s56, 200000
    s_cbranch_scc0 L_nok_nn_1
    s_sleep 8
    buffer_load_dwordx2 v[18:19], v9, s[44:47], 0 offen sc1
    s_waitcnt vmcnt(0)
    s_branch L_nl_nn_1
L_nok_nn_1:

    s_mov_b64 exec, 1
    buffer_store_dwordx2 v[18:19], v9, s[40:43], s74 offen sc1
    s_mov_b64 exec, -1
    v_mfma_f32_16x16x32_bf16 v[148:151], v[84:87], v[116:119], v[148:151]
    ds_read_b128 v[64:67], v15 offset:0
    v_mfma_f32_16x16x32_bf16 v[152:155], v[84:87], v[120:123], v[152:155]
    ds_read_b128 v[68:71], v15 offset:128
    s_add_u32 m0, s62, 86592
    v_mfma_f32_16x16x32_bf16 v[156:159], v[84:87], v[124:127], v[156:159]
    buffer_load_dwordx4 v26, s[8:11], s67 offen lds
    ds_read_b128 v[72:75], v15 offset:256
    v_mfma_f32_16x16x32_bf16 v[208:211], v[100:103], v[112:115], v[208:211]
    ds_read_b128 v[76:79], v15 offset:384
    ds_read_b64_tr_b16 v[48:49], v12 offset:16896
    v_mfma_f32_16x16x32_bf16 v[212:215], v[100:103], v[116:119], v[212:215]
    ds_read_b64_tr_b16 v[50:51], v12 offset:25344
    s_add_u32 m0, s62, 52800
    v_mfma_f32_16x16x32_bf16 v[216:219], v[100:103], v[120:123], v[216:219]
    buffer_load_dwordx4 v22, s[24:27], s66 offen lds
    ds_read_b64_tr_b16 v[36:37], v12 offset:32
    v_mfma_f32_16x16x32_bf16 v[220:223], v[100:103], v[124:127], v[220:223]
    ds_read_b64_tr_b16 v[38:39], v12 offset:8480
    v_mfma_f32_16x16x32_bf16 v[160:163], v[88:91], v[112:115], v[160:163]
    ds_read_b64_tr_b16 v[52:53], v12 offset:16928
    ds_read_b64_tr_b16 v[54:55], v12 offset:25376
    s_add_u32 m0, s62, 69696
    v_mfma_f32_16x16x32_bf16 v[164:167], v[88:91], v[116:119], v[164:167]
    buffer_load_dwordx4 v22, s[28:31], s66 offen lds
    ds_read_b64_tr_b16 v[40:41], v12 offset:64
    v_mfma_f32_16x16x32_bf16 v[168:171], v[88:91], v[120:123], v[168:171]
    ds_read_b64_tr_b16 v[42:43], v12 offset:8512
    v_mfma_f32_16x16x32_bf16 v[172:175], v[88:91], v[124:127], v[172:175]
    ds_read_b64_tr_b16 v[56:57], v12 offset:16960
    s_add_u32 m0, s62, 87648
    v_mfma_f32_16x16x32_bf16 v[224:227], v[104:107], v[112:115], v[224:227]
    buffer_load_dwordx4 v27, s[8:11], s67 offen lds
    ds_read_b64_tr_b16 v[58:59], v12 offset:25408
    ds_read_b64_tr_b16 v[44:45], v12 offset:96
    v_mfma_f32_16x16x32_bf16 v[228:231], v[104:107], v[116:119], v[228:231]
    ds_read_b64_tr_b16 v[46:47], v12 offset:8544
    v_mfma_f32_16x16x32_bf16 v[232:235], v[104:107], v[120:123], v[232:235]
    ds_read_b64_tr_b16 v[60:61], v12 offset:16992
    s_add_u32 m0, s62, 53856
    v_mfma_f32_16x16x32_bf16 v[236:239], v[104:107], v[124:127], v[236:239]
    buffer_load_dwordx4 v23, s[24:27], s66 offen lds
    ds_read_b64_tr_b16 v[62:63], v12 offset:25440
    v_mfma_f32_16x16x32_bf16 v[176:179], v[92:95], v[112:115], v[176:179]
    v_mfma_f32_16x16x32_bf16 v[180:183], v[92:95], v[116:119], v[180:183]
    s_add_u32 m0, s62, 70752
    v_mfma_f32_16x16x32_bf16 v[184:187], v[92:95], v[120:123], v[184:187]
    buffer_load_dwordx4 v23, s[28:31], s66 offen lds
    v_mfma_f32_16x16x32_bf16 v[188:191], v[92:95], v[124:127], v[188:191]
    v_mfma_f32_16x16x32_bf16 v[240:243], v[108:111], v[112:115], v[240:243]
    v_mfma_f32_16x16x32_bf16 v[244:247], v[108:111], v[116:119], v[244:247]
    v_mfma_f32_16x16x32_bf16 v[248:251], v[108:111], v[120:123], v[248:251]
    v_mfma_f32_16x16x32_bf16 v[252:255], v[108:111], v[124:127], v[252:255]
    s_waitcnt lgkmcnt(0)
    v_mfma_f32_16x16x32_bf16 v[128:131], v[32:35], v[64:67], v[128:131]
    ds_read_b64_tr_b16 v[80:81], v12 offset:512
    v_mfma_f32_16x16x32_bf16 v[132:135], v[32:35], v[68:71], v[132:135]
    ds_read_b64_tr_b16 v[82:83], v12 offset:8960
    v_mfma_f32_16x16x32_bf16 v[136:139], v[32:35], v[72:75], v[136:139]
    ds_read_b128 v[112:115], v15 offset:64
    s_mov_b32 s66, 1146880
    s_movk_i32 s67, 640
    s_add_u32 m0, s62, 135168
    v_mfma_f32_16x16x32_bf16 v[140:143], v[32:35], v[76:79], v[140:143]
    buffer_load_dwordx4 v24, s[8:11], s67 offen lds
    ds_read_b128 v[116:119], v15 offset:192
    v_mfma_f32_16x16x32_bf16 v[192:195], v[48:51], v[64:67], v[192:195]
    ds_read_b128 v[120:123], v15 offset:320
    v_mfma_f32_16x16x32_bf16 v[196:199], v[48:51], v[68:71], v[196:199]
    ds_read_b128 v[124:127], v15 offset:448
    v_mfma_f32_16x16x32_bf16 v[200:203], v[48:51], v[72:75], v[200:203]
    ds_read_b64_tr_b16 v[96:97], v12 offset:17408
    s_add_u32 m0, s62, 101376
    v_mfma_f32_16x16x32_bf16 v[204:207], v[48:51], v[76:79], v[204:207]
    buffer_load_dwordx4 v20, s[24:27], s66 offen lds
    ds_read_b64_tr_b16 v[98:99], v12 offset:25856
    v_mfma_f32_16x16x32_bf16 v[144:147], v[36:39], v[64:67], v[144:147]
    ds_read_b64_tr_b16 v[84:85], v12 offset:544
    v_mfma_f32_16x16x32_bf16 v[148:151], v[36:39], v[68:71], v[148:151]
    ds_read_b64_tr_b16 v[86:87], v12 offset:8992
    v_mfma_f32_16x16x32_bf16 v[152:155], v[36:39], v[72:75], v[152:155]
    ds_read_b64_tr_b16 v[100:101], v12 offset:17440
    v_mfma_f32_16x16x32_bf16 v[156:159], v[36:39], v[76:79], v[156:159]
    ds_read_b64_tr_b16 v[102:103], v12 offset:25888
    s_add_u32 m0, s62, 118272
    v_mfma_f32_16x16x32_bf16 v[208:211], v[52:55], v[64:67], v[208:211]
    buffer_load_dwordx4 v20, s[28:31], s66 offen lds
    ds_read_b64_tr_b16 v[88:89], v12 offset:576
    v_mfma_f32_16x16x32_bf16 v[212:215], v[52:55], v[68:71], v[212:215]
    ds_read_b64_tr_b16 v[90:91], v12 offset:9024
    v_mfma_f32_16x16x32_bf16 v[216:219], v[52:55], v[72:75], v[216:219]
    ds_read_b64_tr_b16 v[104:105], v12 offset:17472
    v_mfma_f32_16x16x32_bf16 v[220:223], v[52:55], v[76:79], v[220:223]
    ds_read_b64_tr_b16 v[106:107], v12 offset:25920
    s_add_u32 m0, s62, 136224
    v_mfma_f32_16x16x32_bf16 v[160:163], v[40:43], v[64:67], v[160:163]
    buffer_load_dwordx4 v25, s[8:11], s67 offen lds
    ds_read_b64_tr_b16 v[92:93], v12 offset:608
    v_mfma_f32_16x16x32_bf16 v[164:167], v[40:43], v[68:71], v[164:167]
    ds_read_b64_tr_b16 v[94:95], v12 offset:9056
    v_mfma_f32_16x16x32_bf16 v[168:171], v[40:43], v[72:75], v[168:171]
    ds_read_b64_tr_b16 v[108:109], v12 offset:17504
    v_mfma_f32_16x16x32_bf16 v[172:175], v[40:43], v[76:79], v[172:175]
    ds_read_b64_tr_b16 v[110:111], v12 offset:25952
    v_mfma_f32_16x16x32_bf16 v[224:227], v[56:59], v[64:67], v[224:227]
    s_add_u32 m0, s62, 102432
    v_mfma_f32_16x16x32_bf16 v[228:231], v[56:59], v[68:71], v[228:231]
    buffer_load_dwordx4 v21, s[24:27], s66 offen lds
    v_mfma_f32_16x16x32_bf16 v[232:235], v[56:59], v[72:75], v[232:235]
    v_mfma_f32_16x16x32_bf16 v[236:239], v[56:59], v[76:79], v[236:239]
    v_mfma_f32_16x16x32_bf16 v[176:179], v[44:47], v[64:67], v[176:179]
    s_add_u32 m0, s62, 119328
    v_mfma_f32_16x16x32_bf16 v[180:183], v[44:47], v[68:71], v[180:183]
    buffer_load_dwordx4 v21, s[28:31], s66 offen lds
    v_mfma_f32_16x16x32_bf16 v[184:187], v[44:47], v[72:75], v[184:187]
    v_mfma_f32_16x16x32_bf16 v[188:191], v[44:47], v[76:79], v[188:191]
    v_mfma_f32_16x16x32_bf16 v[240:243], v[60:63], v[64:67], v[240:243]
    v_mfma_f32_16x16x32_bf16 v[244:247], v[60:63], v[68:71], v[244:247]
    v_mfma_f32_16x16x32_bf16 v[248:251], v[60:63], v[72:75], v[248:251]
    v_mfma_f32_16x16x32_bf16 v[252:255], v[60:63], v[76:79], v[252:255]
    s_waitcnt lgkmcnt(0)
    v_mfma_f32_16x16x32_bf16 v[128:131], v[80:83], v[112:115], v[128:131]
    v_mfma_f32_16x16x32_bf16 v[132:135], v[80:83], v[116:119], v[132:135]
    v_mfma_f32_16x16x32_bf16 v[136:139], v[80:83], v[120:123], v[136:139]
    v_mfma_f32_16x16x32_bf16 v[140:143], v[80:83], v[124:127], v[140:143]
    v_mfma_f32_16x16x32_bf16 v[192:195], v[96:99], v[112:115], v[192:195]
    v_mfma_f32_16x16x32_bf16 v[196:199], v[96:99], v[116:119], v[196:199]
    v_mfma_f32_16x16x32_bf16 v[200:203], v[96:99], v[120:123], v[200:203]
    v_mfma_f32_16x16x32_bf16 v[204:207], v[96:99], v[124:127], v[204:207]
    s_waitcnt vmcnt(6)
    s_barrier
    v_mfma_f32_16x16x32_bf16 v[144:147], v[84:87], v[112:115], v[144:147]
    ds_read_b64_tr_b16 v[32:33], v13 offset:0
    ds_read_b64_tr_b16 v[34:35], v13 offset:8448
    v_mfma_f32_16x16x32_bf16 v[148:151], v[84:87], v[116:119], v[148:151]
    ds_read_b128 v[64:67], v16 offset:0
    v_mfma_f32_16x16x32_bf16 v[152:155], v[84:87], v[120:123], v[152:155]
    ds_read_b128 v[68:71], v16 offset:128
    s_add_u32 m0, s62, 137280
    v_mfma_f32_16x16x32_bf16 v[156:159], v[84:87], v[124:127], v[156:159]
    buffer_load_dwordx4 v26, s[8:11], s67 offen lds
    ds_read_b128 v[72:75], v16 offset:256
    v_mfma_f32_16x16x32_bf16 v[208:211], v[100:103], v[112:115], v[208:211]
    ds_read_b128 v[76:79], v16 offset:384
    ds_read_b64_tr_b16 v[48:49], v13 offset:16896
    v_mfma_f32_16x16x32_bf16 v[212:215], v[100:103], v[116:119], v[212:215]
    ds_read_b64_tr_b16 v[50:51], v13 offset:25344
    s_add_u32 m0, s62, 103488
    v_mfma_f32_16x16x32_bf16 v[216:219], v[100:103], v[120:123], v[216:219]
    buffer_load_dwordx4 v22, s[24:27], s66 offen lds
    ds_read_b64_tr_b16 v[36:37], v13 offset:32
    v_mfma_f32_16x16x32_bf16 v[220:223], v[100:103], v[124:127], v[220:223]
    ds_read_b64_tr_b16 v[38:39], v13 offset:8480
    v_mfma_f32_16x16x32_bf16 v[160:163], v[88:91], v[112:115], v[160:163]
    ds_read_b64_tr_b16 v[52:53], v13 offset:16928
    ds_read_b64_tr_b16 v[54:55], v13 offset:25376
    s_add_u32 m0, s62, 120384
    v_mfma_f32_16x16x32_bf16 v[164:167], v[88:91], v[116:119], v[164:167]
    buffer_load_dwordx4 v22, s[28:31], s66 offen lds
    ds_read_b64_tr_b16 v[40:41], v13 offset:64
    v_mfma_f32_16x16x32_bf16 v[168:171], v[88:91], v[120:123], v[168:171]
    ds_read_b64_tr_b16 v[42:43], v13 offset:8512
    v_mfma_f32_16x16x32_bf16 v[172:175], v[88:91], v[124:127], v[172:175]
    ds_read_b64_tr_b16 v[56:57], v13 offset:16960
    s_add_u32 m0, s62, 138336
    v_mfma_f32_16x16x32_bf16 v[224:227], v[104:107], v[112:115], v[224:227]
    buffer_load_dwordx4 v27, s[8:11], s67 offen lds
    ds_read_b64_tr_b16 v[58:59], v13 offset:25408
    ds_read_b64_tr_b16 v[44:45], v13 offset:96
    v_mfma_f32_16x16x32_bf16 v[228:231], v[104:107], v[116:119], v[228:231]
    ds_read_b64_tr_b16 v[46:47], v13 offset:8544
    v_mfma_f32_16x16x32_bf16 v[232:235], v[104:107], v[120:123], v[232:235]
    ds_read_b64_tr_b16 v[60:61], v13 offset:16992
    s_add_u32 m0, s62, 104544
    v_mfma_f32_16x16x32_bf16 v[236:239], v[104:107], v[124:127], v[236:239]
    buffer_load_dwordx4 v23, s[24:27], s66 offen lds
    ds_read_b64_tr_b16 v[62:63], v13 offset:25440
    v_mfma_f32_16x16x32_bf16 v[176:179], v[92:95], v[112:115], v[176:179]
    v_mfma_f32_16x16x32_bf16 v[180:183], v[92:95], v[116:119], v[180:183]
    s_add_u32 m0, s62, 121440
    v_mfma_f32_16x16x32_bf16 v[184:187], v[92:95], v[120:123], v[184:187]
    buffer_load_dwordx4 v23, s[28:31], s66 offen lds
    v_mfma_f32_16x16x32_bf16 v[188:191], v[92:95], v[124:127], v[188:191]
    v_mfma_f32_16x16x32_bf16 v[240:243], v[108:111], v[112:115], v[240:243]
    v_mfma_f32_16x16x32_bf16 v[244:247], v[108:111], v[116:119], v[244:247]
    v_mfma_f32_16x16x32_bf16 v[248:251], v[108:111], v[120:123], v[248:251]
    v_mfma_f32_16x16x32_bf16 v[252:255], v[108:111], v[124:127], v[252:255]
    s_waitcnt lgkmcnt(0)
    v_mfma_f32_16x16x32_bf16 v[128:131], v[32:35], v[64:67], v[128:131]
    ds_read_b64_tr_b16 v[80:81], v13 offset:512
    v_mfma_f32_16x16x32_bf16 v[132:135], v[32:35], v[68:71], v[132:135]
    ds_read_b64_tr_b16 v[82:83], v13 offset:8960
    v_mfma_f32_16x16x32_bf16 v[136:139], v[32:35], v[72:75], v[136:139]
    ds_read_b128 v[112:115], v16 offset:64
    s_mov_b32 s66, 1376256
    s_movk_i32 s67, 768
    s_add_u32 m0, s62, 33792
    v_mfma_f32_16x16x32_bf16 v[140:143], v[32:35], v[76:79], v[140:143]
    buffer_load_dwordx4 v24, s[8:11], s67 offen lds
    ds_read_b128 v[116:119], v16 offset:192
    v_mfma_f32_16x16x32_bf16 v[192:195], v[48:51], v[64:67], v[192:195]
    ds_read_b128 v[120:123], v16 offset:320
    v_mfma_f32_16x16x32_bf16 v[196:199], v[48:51], v[68:71], v[196:199]
    ds_read_b128 v[124:127], v16 offset:448
    v_mfma_f32_16x16x32_bf16 v[200:203], v[48:51], v[72:75], v[200:203]
    ds_read_b64_tr_b16 v[96:97], v13 offset:17408
    s_add_u32 m0, s62, 0
    v_mfma_f32_16x16x32_bf16 v[204:207], v[48:51], v[76:79], v[204:207]
    buffer_load_dwordx4 v20, s[24:27], s66 offen lds
    ds_read_b64_tr_b16 v[98:99], v13 offset:25856
    v_mfma_f32_16x16x32_bf16 v[144:147], v[36:39], v[64:67], v[144:147]
    ds_read_b64_tr_b16 v[84:85], v13 offset:544
    v_mfma_f32_16x16x32_bf16 v[148:151], v[36:39], v[68:71], v[148:151]
    ds_read_b64_tr_b16 v[86:87], v13 offset:8992
    v_mfma_f32_16x16x32_bf16 v[152:155], v[36:39], v[72:75], v[152:155]
    ds_read_b64_tr_b16 v[100:101], v13 offset:17440
    v_mfma_f32_16x16x32_bf16 v[156:159], v[36:39], v[76:79], v[156:159]
    ds_read_b64_tr_b16 v[102:103], v13 offset:25888
    s_add_u32 m0, s62, 16896
    v_mfma_f32_16x16x32_bf16 v[208:211], v[52:55], v[64:67], v[208:211]
    buffer_load_dwordx4 v20, s[28:31], s66 offen lds
    ds_read_b64_tr_b16 v[88:89], v13 offset:576
    v_mfma_f32_16x16x32_bf16 v[212:215], v[52:55], v[68:71], v[212:215]
    ds_read_b64_tr_b16 v[90:91], v13 offset:9024
    v_mfma_f32_16x16x32_bf16 v[216:219], v[52:55], v[72:75], v[216:219]
    ds_read_b64_tr_b16 v[104:105], v13 offset:17472
    v_mfma_f32_16x16x32_bf16 v[220:223], v[52:55], v[76:79], v[220:223]
    ds_read_b64_tr_b16 v[106:107], v13 offset:25920
    s_add_u32 m0, s62, 34848
    v_mfma_f32_16x16x32_bf16 v[160:163], v[40:43], v[64:67], v[160:163]
    buffer_load_dwordx4 v25, s[8:11], s67 offen lds
    ds_read_b64_tr_b16 v[92:93], v13 offset:608
    v_mfma_f32_16x16x32_bf16 v[164:167], v[40:43], v[68:71], v[164:167]
    ds_read_b64_tr_b16 v[94:95], v13 offset:9056
    v_mfma_f32_16x16x32_bf16 v[168:171], v[40:43], v[72:75], v[168:171]
    ds_read_b64_tr_b16 v[108:109], v13 offset:17504
    v_mfma_f32_16x16x32_bf16 v[172:175], v[40:43], v[76:79], v[172:175]
    ds_read_b64_tr_b16 v[110:111], v13 offset:25952
    v_mfma_f32_16x16x32_bf16 v[224:227], v[56:59], v[64:67], v[224:227]
    s_add_u32 m0, s62, 1056
    s_lshl_b32 s56, s4, 12
    v_mfma_f32_16x16x32_bf16 v[228:231], v[56:59], v[68:71], v[228:231]
    buffer_load_dwordx4 v21, s[24:27], s66 offen lds
    s_lshl_b32 s57, s69, 5
    v_mfma_f32_16x16x32_bf16 v[232:235], v[56:59], v[72:75], v[232:235]
    s_mul_i32 s63, s3, 7
    v_mfma_f32_16x16x32_bf16 v[236:239], v[56:59], v[76:79], v[236:239]
    s_add_u32 s57, s57, s63
    v_mfma_f32_16x16x32_bf16 v[176:179], v[44:47], v[64:67], v[176:179]
    s_add_u32 m0, s62, 17952
    v_and_b32 v3, 7, v1
    v_mfma_f32_16x16x32_bf16 v[180:183], v[44:47], v[68:71], v[180:183]
    buffer_load_dwordx4 v21, s[28:31], s66 offen lds
    s_add_u32 s56, s56, s59
    v_mfma_f32_16x16x32_bf16 v[184:187], v[44:47], v[72:75], v[184:187]
    v_lshl_add_u32 v2, v3, 7, s56
    v_mfma_f32_16x16x32_bf16 v[188:191], v[44:47], v[76:79], v[188:191]
    v_min_u32 v3, 6, v3
    v_mfma_f32_16x16x32_bf16 v[240:243], v[60:63], v[64:67], v[240:243]
    v_cmp_gt_u32 vcc, 32, v1
    v_mfma_f32_16x16x32_bf16 v[244:247], v[60:63], v[68:71], v[244:247]
    v_add_lshl_u32 v3, v3, s57, 7
    v_mfma_f32_16x16x32_bf16 v[248:251], v[60:63], v[72:75], v[248:251]
    s_nop 0
    v_mfma_f32_16x16x32_bf16 v[252:255], v[60:63], v[76:79], v[252:255]
    v_cndmask_b32 v8, v3, v2, vcc
    s_waitcnt lgkmcnt(0)
    v_mfma_f32_16x16x32_bf16 v[128:131], v[80:83], v[112:115], v[128:131]
    buffer_load_dwordx2 v[6:7], v8, s[40:43], 0 offen sc1
    v_mfma_f32_16x16x32_bf16 v[132:135], v[80:83], v[116:119], v[132:135]
    v_mfma_f32_16x16x32_bf16 v[136:139], v[80:83], v[120:123], v[136:139]
    v_mfma_f32_16x16x32_bf16 v[140:143], v[80:83], v[124:127], v[140:143]
    v_mfma_f32_16x16x32_bf16 v[192:195], v[96:99], v[112:115], v[192:195]
    v_mfma_f32_16x16x32_bf16 v[196:199], v[96:99], v[116:119], v[196:199]
    v_mfma_f32_16x16x32_bf16 v[200:203], v[96:99], v[120:123], v[200:203]
    v_mfma_f32_16x16x32_bf16 v[204:207], v[96:99], v[124:127], v[204:207]
    s_waitcnt vmcnt(7)
    s_barrier
    v_mfma_f32_16x16x32_bf16 v[144:147], v[84:87], v[112:115], v[144:147]
    ds_read_b64_tr_b16 v[32:33], v14 offset:0
    ds_read_b64_tr_b16 v[34:35], v14 offset:8448
    v_mfma_f32_16x16x32_bf16 v[148:151], v[84:87], v[116:119], v[148:151]
    ds_read_b128 v[64:67], v17 offset:0
    v_mfma_f32_16x16x32_bf16 v[152:155], v[84:87], v[120:123], v[152:155]
    ds_read_b128 v[68:71], v17 offset:128
    s_add_u32 m0, s62, 35904
    v_mfma_f32_16x16x32_bf16 v[156:159], v[84:87], v[124:127], v[156:159]
    buffer_load_dwordx4 v26, s[8:11], s67 offen lds
    ds_read_b128 v[72:75], v17 offset:256
    v_mfma_f32_16x16x32_bf16 v[208:211], v[100:103], v[112:115], v[208:211]
    ds_read_b128 v[76:79], v17 offset:384
    ds_read_b64_tr_b16 v[48:49], v14 offset:16896
    v_mfma_f32_16x16x32_bf16 v[212:215], v[100:103], v[116:119], v[212:215]
    ds_read_b64_tr_b16 v[50:51], v14 offset:25344
    s_add_u32 m0, s62, 2112
    v_mfma_f32_16x16x32_bf16 v[216:219], v[100:103], v[120:123], v[216:219]
    buffer_load_dwordx4 v22, s[24:27], s66 offen lds
    ds_read_b64_tr_b16 v[36:37], v14 offset:32
    v_mfma_f32_16x16x32_bf16 v[220:223], v[100:103], v[124:127], v[220:223]
    ds_read_b64_tr_b16 v[38:39], v14 offset:8480
    v_mfma_f32_16x16x32_bf16 v[160:163], v[88:91], v[112:115], v[160:163]
    ds_read_b64_tr_b16 v[52:53], v14 offset:16928
    ds_read_b64_tr_b16 v[54:55], v14 offset:25376
    s_add_u32 m0, s62, 19008
    v_mfma_f32_16x16x32_bf16 v[164:167], v[88:91], v[116:119], v[164:167]
    buffer_load_dwordx4 v22, s[28:31], s66 offen lds
    ds_read_b64_tr_b16 v[40:41], v14 offset:64
    v_mfma_f32_16x16x32_bf16 v[168:171], v[88:91], v[120:123], v[168:171]
    ds_read_b64_tr_b16 v[42:43], v14 offset:8512
    v_mfma_f32_16x16x32_bf16 v[172:175], v[88:91], v[124:127], v[172:175]
    ds_read_b64_tr_b16 v[56:57], v14 offset:16960
    s_add_u32 m0, s62, 36960
    v_mfma_f32_16x16x32_bf16 v[224:227], v[104:107], v[112:115], v[224:227]
    buffer_load_dwordx4 v27, s[8:11], s67 offen lds
    ds_read_b64_tr_b16 v[58:59], v14 offset:25408
    ds_read_b64_tr_b16 v[44:45], v14 offset:96
    v_mfma_f32_16x16x32_bf16 v[228:231], v[104:107], v[116:119], v[228:231]
    ds_read_b64_tr_b16 v[46:47], v14 offset:8544
    v_mfma_f32_16x16x32_bf16 v[232:235], v[104:107], v[120:123], v[232:235]
    ds_read_b64_tr_b16 v[60:61], v14 offset:16992
    s_add_u32 m0, s62, 3168
    v_mfma_f32_16x16x32_bf16 v[236:239], v[104:107], v[124:127], v[236:239]
    buffer_load_dwordx4 v23, s[24:27], s66 offen lds
    ds_read_b64_tr_b16 v[62:63], v14 offset:25440
    v_mfma_f32_16x16x32_bf16 v[176:179], v[92:95], v[112:115], v[176:179]
    v_mfma_f32_16x16x32_bf16 v[180:183], v[92:95], v[116:119], v[180:183]
    s_add_u32 m0, s62, 20064
    v_mfma_f32_16x16x32_bf16 v[184:187], v[92:95], v[120:123], v[184:187]
    buffer_load_dwordx4 v23, s[28:31], s66 offen lds
    v_mfma_f32_16x16x32_bf16 v[188:191], v[92:95], v[124:127], v[188:191]
    v_mfma_f32_16x16x32_bf16 v[240:243], v[108:111], v[112:115], v[240:243]
    v_mfma_f32_16x16x32_bf16 v[244:247], v[108:111], v[116:119], v[244:247]
    v_mfma_f32_16x16x32_bf16 v[248:251], v[108:111], v[120:123], v[248:251]
    v_mfma_f32_16x16x32_bf16 v[252:255], v[108:111], v[124:127], v[252:255]
    s_waitcnt lgkmcnt(0)
    v_mfma_f32_16x16x32_bf16 v[128:131], v[32:35], v[64:67], v[128:131]
    ds_read_b64_tr_b16 v[80:81], v14 offset:512
    v_mfma_f32_16x16x32_bf16 v[132:135], v[32:35], v[68:71], v[132:135]
    ds_read_b64_tr_b16 v[82:83], v14 offset:8960
    v_mfma_f32_16x16x32_bf16 v[136:139], v[32:35], v[72:75], v[136:139]
    ds_read_b128 v[112:115], v17 offset:64
    s_mov_b32 s66, 1605632
    s_movk_i32 s67, 896
    s_add_u32 m0, s62, 84480
    v_mfma_f32_16x16x32_bf16 v[140:143], v[32:35], v[76:79], v[140:143]
    buffer_load_dwordx4 v24, s[8:11], s67 offen lds
    ds_read_b128 v[116:119], v17 offset:192
    v_mfma_f32_16x16x32_bf16 v[192:195], v[48:51], v[64:67], v[192:195]
    ds_read_b128 v[120:123], v17 offset:320
    v_mfma_f32_16x16x32_bf16 v[196:199], v[48:51], v[68:71], v[196:199]
    ds_read_b128 v[124:127], v17 offset:448
    v_mfma_f32_16x16x32_bf16 v[200:203], v[48:51], v[72:75], v[200:203]
    ds_read_b64_tr_b16 v[96:97], v14 offset:17408
    s_add_u32 m0, s62, 50688
    v_mfma_f32_16x16x32_bf16 v[204:207], v[48:51], v[76:79], v[204:207]
    buffer_load_dwordx4 v20, s[24:27], s66 offen lds
    ds_read_b64_tr_b16 v[98:99], v14 offset:25856
    v_mfma_f32_16x16x32_bf16 v[144:147], v[36:39], v[64:67], v[144:147]
    ds_read_b64_tr_b16 v[84:85], v14 offset:544
    v_mfma_f32_16x16x32_bf16 v[148:151], v[36:39], v[68:71], v[148:151]
    ds_read_b64_tr_b16 v[86:87], v14 offset:8992
    v_mfma_f32_16x16x32_bf16 v[152:155], v[36:39], v[72:75], v[152:155]
    ds_read_b64_tr_b16 v[100:101], v14 offset:17440
    v_mfma_f32_16x16x32_bf16 v[156:159], v[36:39], v[76:79], v[156:159]
    ds_read_b64_tr_b16 v[102:103], v14 offset:25888
    s_add_u32 m0, s62, 67584
    v_mfma_f32_16x16x32_bf16 v[208:211], v[52:55], v[64:67], v[208:211]
    buffer_load_dwordx4 v20, s[28:31], s66 offen lds
    ds_read_b64_tr_b16 v[88:89], v14 offset:576
    v_mfma_f32_16x16x32_bf16 v[212:215], v[52:55], v[68:71], v[212:215]
    ds_read_b64_tr_b16 v[90:91], v14 offset:9024
    v_mfma_f32_16x16x32_bf16 v[216:219], v[52:55], v[72:75], v[216:219]
    ds_read_b64_tr_b16 v[104:105], v14 offset:17472
    v_mfma_f32_16x16x32_bf16 v[220:223], v[52:55], v[76:79], v[220:223]
    ds_read_b64_tr_b16 v[106:107], v14 offset:25920
    s_add_u32 m0, s62, 85536
    v_mfma_f32_16x16x32_bf16 v[160:163], v[40:43], v[64:67], v[160:163]
    buffer_load_dwordx4 v25, s[8:11], s67 offen lds
    ds_read_b64_tr_b16 v[92:93], v14 offset:608
    v_mfma_f32_16x16x32_bf16 v[164:167], v[40:43], v[68:71], v[164:167]
    ds_read_b64_tr_b16 v[94:95], v14 offset:9056
    v_mfma_f32_16x16x32_bf16 v[168:171], v[40:43], v[72:75], v[168:171]
    ds_read_b64_tr_b16 v[108:109], v14 offset:17504
    v_mfma_f32_16x16x32_bf16 v[172:175], v[40:43], v[76:79], v[172:175]
    ds_read_b64_tr_b16 v[110:111], v14 offset:25952
    v_mfma_f32_16x16x32_bf16 v[224:227], v[56:59], v[64:67], v[224:227]
    s_add_u32 m0, s62, 51744
    v_mfma_f32_16x16x32_bf16 v[228:231], v[56:59], v[68:71], v[228:231]
    buffer_load_dwordx4 v21, s[24:27], s66 offen lds
    v_mfma_f32_16x16x32_bf16 v[232:235], v[56:59], v[72:75], v[232:235]
    v_mfma_f32_16x16x32_bf16 v[236:239], v[56:59], v[76:79], v[236:239]
    v_mfma_f32_16x16x32_bf16 v[176:179], v[44:47], v[64:67], v[176:179]
    s_add_u32 m0, s62, 68640
    v_mfma_f32_16x16x32_bf16 v[180:183], v[44:47], v[68:71], v[180:183]
    buffer_load_dwordx4 v21, s[28:31], s66 offen lds
    v_mfma_f32_16x16x32_bf16 v[184:187], v[44:47], v[72:75], v[184:187]
    v_mfma_f32_16x16x32_bf16 v[188:191], v[44:47], v[76:79], v[188:191]
    v_mfma_f32_16x16x32_bf16 v[240:243], v[60:63], v[64:67], v[240:243]
    v_mfma_f32_16x16x32_bf16 v[244:247], v[60:63], v[68:71], v[244:247]
    v_mfma_f32_16x16x32_bf16 v[248:251], v[60:63], v[72:75], v[248:251]
    v_mfma_f32_16x16x32_bf16 v[252:255], v[60:63], v[76:79], v[252:255]
    s_waitcnt lgkmcnt(0)
    v_mfma_f32_16x16x32_bf16 v[128:131], v[80:83], v[112:115], v[128:131]
    v_mfma_f32_16x16x32_bf16 v[132:135], v[80:83], v[116:119], v[132:135]
    v_mfma_f32_16x16x32_bf16 v[136:139], v[80:83], v[120:123], v[136:139]
    v_mfma_f32_16x16x32_bf16 v[140:143], v[80:83], v[124:127], v[140:143]
    v_mfma_f32_16x16x32_bf16 v[192:195], v[96:99], v[112:115], v[192:195]
    v_mfma_f32_16x16x32_bf16 v[196:199], v[96:99], v[116:119], v[196:199]
    v_mfma_f32_16x16x32_bf16 v[200:203], v[96:99], v[120:123], v[200:203]
    v_mfma_f32_16x16x32_bf16 v[204:207], v[96:99], v[124:127], v[204:207]
    s_waitcnt vmcnt(6)
    v_cmp_ne_u64 vcc, s[54:55], v[6:7]
    s_mov_b32 s56, 0
    s_cmp_eq_u64 vcc, 0
    s_cbranch_scc1 L_ok_pl_2
L_re_pl_2:
    s_sleep 4
    buffer_load_dwordx2 v[6:7], v8, s[40:43], 0 offen sc1
    s_waitcnt vmcnt(0)
    v_cmp_ne_u64 vcc, s[54:55], v[6:7]
    s_add_u32 s56, s56, 1
    s_cmp_eq_u64 vcc, 0
    s_cbranch_scc1 L_ok_pl_2
    s_cmp_lt_u32 s56, 200000
    s_cbranch_scc1 L_re_pl_2
L_ok_pl_2:
    s_barrier
    v_mfma_f32_16x16x32_bf16 v[144:147], v[84:87], v[112:115], v[144:147]
    ds_read_b64_tr_b16 v[32:33], v12 offset:0
    ds_read_b64_tr_b16 v[34:35], v12 offset:8448
    v_mfma_f32_16x16x32_bf16 v[148:151], v[84:87], v[116:119], v[148:151]
    ds_read_b128 v[64:67], v15 offset:0
    v_mfma_f32_16x16x32_bf16 v[152:155], v[84:87], v[120:123], v[152:155]
    ds_read_b128 v[68:71], v15 offset:128
    s_add_u32 m0, s62, 86592
    v_mfma_f32_16x16x32_bf16 v[156:159], v[84:87], v[124:127], v[156:159]
    buffer_load_dwordx4 v26, s[8:11], s67 offen lds
    ds_read_b128 v[72:75], v15 offset:256
    v_mfma_f32_16x16x32_bf16 v[208:211], v[100:103], v[112:115], v[208:211]
    ds_read_b128 v[76:79], v15 offset:384
    ds_read_b64_tr_b16 v[48:49], v12 offset:16896
    v_mfma_f32_16x16x32_bf16 v[212:215], v[100:103], v[116:119], v[212:215]
    ds_read_b64_tr_b16 v[50:51], v12 offset:25344
    s_add_u32 m0, s62, 52800
    v_mfma_f32_16x16x32_bf16 v[216:219], v[100:103], v[120:123], v[216:219]
    buffer_load_dwordx4 v22, s[24:27], s66 offen lds
    ds_read_b64_tr_b16 v[36:37], v12 offset:32
    v_mfma_f32_16x16x32_bf16 v[220:223], v[100:103], v[124:127], v[220:223]
    ds_read_b64_tr_b16 v[38:39], v12 offset:8480
    v_mfma_f32_16x16x32_bf16 v[160:163], v[88:91], v[112:115], v[160:163]
    ds_read_b64_tr_b16 v[52:53], v12 offset:16928
    ds_read_b64_tr_b16 v[54:55], v12 offset:25376
    s_add_u32 m0, s62, 69696
    v_mfma_f32_16x16x32_bf16 v[164:167], v[88:91], v[116:119], v[164:167]
    buffer_load_dwordx4 v22, s[28:31], s66 offen lds
    ds_read_b64_tr_b16 v[40:41], v12 offset:64
    v_mfma_f32_16x16x32_bf16 v[168:171], v[88:91], v[120:123], v[168:171]
    ds_read_b64_tr_b16 v[42:43], v12 offset:8512
    v_mfma_f32_16x16x32_bf16 v[172:175], v[88:91], v[124:127], v[172:175]
    ds_read_b64_tr_b16 v[56:57], v12 offset:16960
    s_add_u32 m0, s62, 87648
    v_mfma_f32_16x16x32_bf16 v[224:227], v[104:107], v[112:115], v[224:227]
    buffer_load_dwordx4 v27, s[8:11], s67 offen lds
    ds_read_b64_tr_b16 v[58:59], v12 offset:25408
    ds_read_b64_tr_b16 v[44:45], v12 offset:96
    v_mfma_f32_16x16x32_bf16 v[228:231], v[104:107], v[116:119], v[228:231]
    ds_read_b64_tr_b16 v[46:47], v12 offset:8544
    v_mfma_f32_16x16x32_bf16 v[232:235], v[104:107], v[120:123], v[232:235]
    ds_read_b64_tr_b16 v[60:61], v12 offset:16992
    s_add_u32 m0, s62, 53856
    v_mfma_f32_16x16x32_bf16 v[236:239], v[104:107], v[124:127], v[236:239]
    buffer_load_dwordx4 v23, s[24:27], s66 offen lds
    ds_read_b64_tr_b16 v[62:63], v12 offset:25440
    v_mfma_f32_16x16x32_bf16 v[176:179], v[92:95], v[112:115], v[176:179]
    v_mfma_f32_16x16x32_bf16 v[180:183], v[92:95], v[116:119], v[180:183]
    s_add_u32 m0, s62, 70752
    v_mfma_f32_16x16x32_bf16 v[184:187], v[92:95], v[120:123], v[184:187]
    buffer_load_dwordx4 v23, s[28:31], s66 offen lds
    v_mfma_f32_16x16x32_bf16 v[188:191], v[92:95], v[124:127], v[188:191]
    v_mfma_f32_16x16x32_bf16 v[240:243], v[108:111], v[112:115], v[240:243]
    v_mfma_f32_16x16x32_bf16 v[244:247], v[108:111], v[116:119], v[244:247]
    v_mfma_f32_16x16x32_bf16 v[248:251], v[108:111], v[120:123], v[248:251]
    v_mfma_f32_16x16x32_bf16 v[252:255], v[108:111], v[124:127], v[252:255]
    s_waitcnt lgkmcnt(0)
    v_mfma_f32_16x16x32_bf16 v[128:131], v[32:35], v[64:67], v[128:131]
    ds_read_b64_tr_b16 v[80:81], v12 offset:512
    v_mfma_f32_16x16x32_bf16 v[132:135], v[32:35], v[68:71], v[132:135]
    ds_read_b64_tr_b16 v[82:83], v12 offset:8960
    s_mul_i32 s71, s69, 56
    s_mul_i32 s56, s3, 14
    s_add_u32 s71, s71, s56
    s_lshl_b32 s71, s71, 12
    s_add_u32 s100, s71, 8388608
    s_lshl_b32 s56, s58, 13
    s_lshl_b32 s57, s3, 11
    s_add_u32 s56, s56, s57
    s_add_u32 s63, s56, 1048576
    v_mfma_f32_16x16x32_bf16 v[136:139], v[32:35], v[72:75], v[136:139]
    ds_read_b128 v[112:115], v15 offset:64
    buffer_load_dwordx4 v[20:23], v10, s[40:43], s63 offen sc1
    v_mfma_f32_16x16x32_bf16 v[140:143], v[32:35], v[76:79], v[140:143]
    ds_read_b128 v[116:119], v15 offset:192
    v_mfma_f32_16x16x32_bf16 v[192:195], v[48:51], v[64:67], v[192:195]
    ds_read_b128 v[120:123], v15 offset:320
    buffer_load_dword v24, v10, s[40:43], s63 offen offset:16 sc1
    v_mfma_f32_16x16x32_bf16 v[196:199], v[48:51], v[68:71], v[196:199]
    ds_read_b128 v[124:127], v15 offset:448
    v_mfma_f32_16x16x32_bf16 v[200:203], v[48:51], v[72:75], v[200:203]
    ds_read_b64_tr_b16 v[96:97], v12 offset:17408
    buffer_load_dwordx4 v[28:31], v10, s[40:43], s63 offen offset:1024 sc1
    v_mfma_f32_16x16x32_bf16 v[204:207], v[48:51], v[76:79], v[204:207]
    ds_read_b64_tr_b16 v[98:99], v12 offset:25856
    v_mfma_f32_16x16x32_bf16 v[144:147], v[36:39], v[64:67], v[144:147]
    ds_read_b64_tr_b16 v[84:85], v12 offset:544
    buffer_load_dword v25, v10, s[40:43], s63 offen offset:1040 sc1
    v_mfma_f32_16x16x32_bf16 v[148:151], v[36:39], v[68:71], v[148:151]
    ds_read_b64_tr_b16 v[86:87], v12 offset:8992
    v_mfma_f32_16x16x32_bf16 v[152:155], v[36:39], v[72:75], v[152:155]
    ds_read_b64_tr_b16 v[100:101], v12 offset:17440
    v_mfma_f32_16x16x32_bf16 v[156:159], v[36:39], v[76:79], v[156:159]
    ds_read_b64_tr_b16 v[102:103], v12 offset:25888
    v_mfma_f32_16x16x32_bf16 v[208:211], v[52:55], v[64:67], v[208:211]
    ds_read_b64_tr_b16 v[88:89], v12 offset:576
    s_add_u32 s71, s100, 0
    buffer_load_dwordx4 a[0:3], v10, s[40:43], s71 offen offset:0 sc1
    v_mfma_f32_16x16x32_bf16 v[212:215], v[52:55], v[68:71], v[212:215]
    ds_read_b64_tr_b16 v[90:91], v12 offset:9024
    v_mfma_f32_16x16x32_bf16 v[216:219], v[52:55], v[72:75], v[216:219]
    ds_read_b64_tr_b16 v[104:105], v12 offset:17472
    v_mfma_f32_16x16x32_bf16 v[220:223], v[52:55], v[76:79], v[220:223]
    ds_read_b64_tr_b16 v[106:107], v12 offset:25920
    buffer_load_dwordx4 a[4:7], v10, s[40:43], s71 offen offset:1024 sc1
    v_mfma_f32_16x16x32_bf16 v[160:163], v[40:43], v[64:67], v[160:163]
    ds_read_b64_tr_b16 v[92:93], v12 offset:608
    v_mfma_f32_16x16x32_bf16 v[164:167], v[40:43], v[68:71], v[164:167]
    ds_read_b64_tr_b16 v[94:95], v12 offset:9056
    v_mfma_f32_16x16x32_bf16 v[168:171], v[40:43], v[72:75], v[168:171]
    ds_read_b64_tr_b16 v[108:109], v12 offset:17504
    buffer_load_dwordx4 a[8:11], v10, s[40:43], s71 offen offset:2048 sc1
    v_mfma_f32_16x16x32_bf16 v[172:175], v[40:43], v[76:79], v[172:175]
    ds_read_b64_tr_b16 v[110:111], v12 offset:25952
    v_mfma_f32_16x16x32_bf16 v[224:227], v[56:59], v[64:67], v[224:227]
    v_mfma_f32_16x16x32_bf16 v[228:231], v[56:59], v[68:71], v[228:231]
    v_mfma_f32_16x16x32_bf16 v[232:235], v[56:59], v[72:75], v[232:235]
    buffer_load_dwordx4 a[12:15], v10, s[40:43], s71 offen offset:3072 sc1
    v_mfma_f32_16x16x32_bf16 v[236:239], v[56:59], v[76:79], v[236:239]
    v_mfma_f32_16x16x32_bf16 v[176:179], v[44:47], v[64:67], v[176:179]
    v_mfma_f32_16x16x32_bf16 v[180:183], v[44:47], v[68:71], v[180:183]
    s_add_u32 s71, s100, 4096
    buffer_load_dwordx4 a[16:19], v10, s[40:43], s71 offen offset:0 sc1
    v_mfma_f32_16x16x32_bf16 v[184:187], v[44:47], v[72:75], v[184:187]
    v_mfma_f32_16x16x32_bf16 v[188:191], v[44:47], v[76:79], v[188:191]
    v_mfma_f32_16x16x32_bf16 v[240:243], v[60:63], v[64:67], v[240:243]
    buffer_load_dwordx4 a[20:23], v10, s[40:43], s71 offen offset:1024 sc1
    v_mfma_f32_16x16x32_bf16 v[244:247], v[60:63], v[68:71], v[244:247]
    v_mfma_f32_16x16x32_bf16 v[248:251], v[60:63], v[72:75], v[248:251]
    v_mfma_f32_16x16x32_bf16 v[252:255], v[60:63], v[76:79], v[252:255]
    s_waitcnt lgkmcnt(0)
    v_mfma_f32_16x16x32_bf16 v[128:131], v[80:83], v[112:115], v[128:131]
    v_mfma_f32_16x16x32_bf16 v[132:135], v[80:83], v[116:119], v[132:135]
    v_mfma_f32_16x16x32_bf16 v[136:139], v[80:83], v[120:123], v[136:139]
    buffer_load_dwordx4 a[24:27], v10, s[40:43], s71 offen offset:2048 sc1
    v_mfma_f32_16x16x32_bf16 v[140:143], v[80:83], v[124:127], v[140:143]
    v_mfma_f32_16x16x32_bf16 v[192:195], v[96:99], v[112:115], v[192:195]
    v_mfma_f32_16x16x32_bf16 v[196:199], v[96:99], v[116:119], v[196:199]
    buffer_load_dwordx4 a[28:31], v10, s[40:43], s71 offen offset:3072 sc1
    v_mfma_f32_16x16x32_bf16 v[200:203], v[96:99], v[120:123], v[200:203]
    v_mfma_f32_16x16x32_bf16 v[204:207], v[96:99], v[124:127], v[204:207]
    s_waitcnt vmcnt(12)
    s_barrier
    v_mfma_f32_16x16x32_bf16 v[144:147], v[84:87], v[112:115], v[144:147]
    ds_read_b64_tr_b16 v[32:33], v13 offset:0
    ds_read_b64_tr_b16 v[34:35], v13 offset:8448
    s_add_u32 s71, s100, 8192
    buffer_load_dwordx4 a[32:35], v10, s[40:43], s71 offen offset:0 sc1
    v_mfma_f32_16x16x32_bf16 v[148:151], v[84:87], v[116:119], v[148:151]
    ds_read_b128 v[64:67], v16 offset:0
    v_mfma_f32_16x16x32_bf16 v[152:155], v[84:87], v[120:123], v[152:155]
    ds_read_b128 v[68:71], v16 offset:128
    v_mfma_f32_16x16x32_bf16 v[156:159], v[84:87], v[124:127], v[156:159]
    ds_read_b128 v[72:75], v16 offset:256
    v_mfma_f32_16x16x32_bf16 v[208:211], v[100:103], v[112:115], v[208:211]
    ds_read_b128 v[76:79], v16 offset:384
    ds_read_b64_tr_b16 v[48:49], v13 offset:16896
    buffer_load_dwordx4 a[36:39], v10, s[40:43], s71 offen offset:1024 sc1
    v_mfma_f32_16x16x32_bf16 v[212:215], v[100:103], v[116:119], v[212:215]
    ds_read_b64_tr_b16 v[50:51], v13 offset:25344
    v_mfma_f32_16x16x32_bf16 v[216:219], v[100:103], v[120:123], v[216:219]
    ds_read_b64_tr_b16 v[36:37], v13 offset:32
    v_mfma_f32_16x16x32_bf16 v[220:223], v[100:103], v[124:127], v[220:223]
    ds_read_b64_tr_b16 v[38:39], v13 offset:8480
    buffer_load_dwordx4 a[40:43], v10, s[40:43], s71 offen offset:2048 sc1
    v_mfma_f32_16x16x32_bf16 v[160:163], v[88:91], v[112:115], v[160:163]
    ds_read_b64_tr_b16 v[52:53], v13 offset:16928
    ds_read_b64_tr_b16 v[54:55], v13 offset:25376
    v_mfma_f32_16x16x32_bf16 v[164:167], v[88:91], v[116:119], v[164:167]
    ds_read_b64_tr_b16 v[40:41], v13 offset:64
    v_mfma_f32_16x16x32_bf16 v[168:171], v[88:91], v[120:123], v[168:171]
    ds_read_b64_tr_b16 v[42:43], v13 offset:8512
    buffer_load_dwordx4 a[44:47], v10, s[40:43], s71 offen offset:3072 sc1
    v_mfma_f32_16x16x32_bf16 v[172:175], v[88:91], v[124:127], v[172:175]
    ds_read_b64_tr_b16 v[56:57], v13 offset:16960
    v_mfma_f32_16x16x32_bf16 v[224:227], v[104:107], v[112:115], v[224:227]
    ds_read_b64_tr_b16 v[58:59], v13 offset:25408
    ds_read_b64_tr_b16 v[44:45], v13 offset:96
    v_mfma_f32_16x16x32_bf16 v[228:231], v[104:107], v[116:119], v[228:231]
    ds_read_b64_tr_b16 v[46:47], v13 offset:8544
    v_mfma_f32_16x16x32_bf16 v[232:235], v[104:107], v[120:123], v[232:235]
    ds_read_b64_tr_b16 v[60:61], v13 offset:16992
    s_add_u32 s71, s100, 12288
    buffer_load_dwordx4 a[48:51], v10, s[40:43], s71 offen offset:0 sc1
    v_mfma_f32_16x16x32_bf16 v[236:239], v[104:107], v[124:127], v[236:239]
    ds_read_b64_tr_b16 v[62:63], v13 offset:25440
    v_mfma_f32_16x16x32_bf16 v[176:179], v[92:95], v[112:115], v[176:179]
    v_mfma_f32_16x16x32_bf16 v[180:183], v[92:95], v[116:119], v[180:183]
    buffer_load_dwordx4 a[52:55], v10, s[40:43], s71 offen offset:1024 sc1
    v_mfma_f32_16x16x32_bf16 v[184:187], v[92:95], v[120:123], v[184:187]
    v_mfma_f32_16x16x32_bf16 v[188:191], v[92:95], v[124:127], v[188:191]
    v_mfma_f32_16x16x32_bf16 v[240:243], v[108:111], v[112:115], v[240:243]
    buffer_load_dwordx4 a[56:59], v10, s[40:43], s71 offen offset:2048 sc1
    v_mfma_f32_16x16x32_bf16 v[244:247], v[108:111], v[116:119], v[244:247]
    v_mfma_f32_16x16x32_bf16 v[248:251], v[108:111], v[120:123], v[248:251]
    v_mfma_f32_16x16x32_bf16 v[252:255], v[108:111], v[124:127], v[252:255]
    s_waitcnt lgkmcnt(0)
    v_mfma_f32_16x16x32_bf16 v[128:131], v[32:35], v[64:67], v[128:131]
    ds_read_b64_tr_b16 v[80:81], v13 offset:512
    v_mfma_f32_16x16x32_bf16 v[132:135], v[32:35], v[68:71], v[132:135]
    ds_read_b64_tr_b16 v[82:83], v13 offset:8960
    v_mfma_f32_16x16x32_bf16 v[136:139], v[32:35], v[72:75], v[136:139]
    ds_read_b128 v[112:115], v16 offset:64
    buffer_load_dwordx4 a[60:63], v10, s[40:43], s71 offen offset:3072 sc1
    s_mul_i32 s56, s65, 8320
    s_lshl_b32 s57, s64, 11
    v_mfma_f32_16x16x32_bf16 v[140:143], v[32:35], v[76:79], v[140:143]
    ds_read_b128 v[116:119], v16 offset:192
    s_add_u32 s57, s57, s56
    v_mfma_f32_16x16x32_bf16 v[192:195], v[48:51], v[64:67], v[192:195]
    ds_read_b128 v[120:123], v16 offset:320
    s_add_u32 s57, s57, 101376
    v_mfma_f32_16x16x32_bf16 v[196:199], v[48:51], v[68:71], v[196:199]
    ds_read_b128 v[124:127], v16 offset:448
    s_add_u32 s71, s100, 16384
    buffer_load_dwordx4 a[64:67], v10, s[40:43], s71 offen offset:0 sc1
    v_add_u32 v2, s57, v10
    v_mfma_f32_16x16x32_bf16 v[200:203], v[48:51], v[72:75], v[200:203]
    ds_read_b64_tr_b16 v[96:97], v13 offset:17408
    v_bfe_u32 v3, v1, 4, 1
    v_mfma_f32_16x16x32_bf16 v[204:207], v[48:51], v[76:79], v[204:207]
    ds_read_b64_tr_b16 v[98:99], v13 offset:25856
    v_mul_u32_u24 v3, 4160, v3
    v_mfma_f32_16x16x32_bf16 v[144:147], v[36:39], v[64:67], v[144:147]
    ds_read_b64_tr_b16 v[84:85], v13 offset:544
    buffer_load_dwordx4 a[68:71], v10, s[40:43], s71 offen offset:1024 sc1
    v_and_b32 v4, 15, v1
    v_lshl_add_u32 v3, v4, 2, v3
    v_mfma_f32_16x16x32_bf16 v[148:151], v[36:39], v[68:71], v[148:151]
    ds_read_b64_tr_b16 v[86:87], v13 offset:8992
    s_add_u32 s57, s56, 105472
    v_mfma_f32_16x16x32_bf16 v[152:155], v[36:39], v[72:75], v[152:155]
    ds_read_b64_tr_b16 v[100:101], v13 offset:17440
    v_add_u32 v3, s57, v3
    v_mfma_f32_16x16x32_bf16 v[156:159], v[36:39], v[76:79], v[156:159]
    ds_read_b64_tr_b16 v[102:103], v13 offset:25888
    v_and_b32 v6, 127, v0
    v_mfma_f32_16x16x32_bf16 v[208:211], v[52:55], v[64:67], v[208:211]
    ds_read_b64_tr_b16 v[88:89], v13 offset:576
    buffer_load_dwordx4 a[72:75], v10, s[40:43], s71 offen offset:2048 sc1
    v_cmp_eq_u32 vcc, 127, v6
    v_mfma_f32_16x16x32_bf16 v[212:215], v[52:55], v[68:71], v[212:215]
    ds_read_b64_tr_b16 v[90:91], v13 offset:9024
    ds_write_b32 v3, v9
    v_mfma_f32_16x16x32_bf16 v[216:219], v[52:55], v[72:75], v[216:219]
    ds_read_b64_tr_b16 v[104:105], v13 offset:17472
    v_mfma_f32_16x16x32_bf16 v[220:223], v[52:55], v[76:79], v[220:223]
    ds_read_b64_tr_b16 v[106:107], v13 offset:25920
    buffer_load_dwordx4 a[76:79], v10, s[40:43], s71 offen offset:3072 sc1
    v_mfma_f32_16x16x32_bf16 v[160:163], v[40:43], v[64:67], v[160:163]
    ds_read_b64_tr_b16 v[92:93], v13 offset:608
    s_waitcnt vmcnt(20)
    ds_write_b128 v2, v[20:23]
    v_mfma_f32_16x16x32_bf16 v[164:167], v[40:43], v[68:71], v[164:167]
    ds_read_b64_tr_b16 v[94:95], v13 offset:9056
    ds_write_b128 v2, v[28:31] offset:1024
    v_cndmask_b32 v25, v25, v9, vcc
    v_mfma_f32_16x16x32_bf16 v[168:171], v[40:43], v[72:75], v[168:171]
    ds_read_b64_tr_b16 v[108:109], v13 offset:17504
    s_add_u32 s71, s100, 20480
    buffer_load_dwordx4 a[80:83], v10, s[40:43], s71 offen offset:0 sc1
    v_alignbit_b32 v4, v21, v20, 16
    v_alignbit_b32 v5, v22, v21, 16
    v_mfma_f32_16x16x32_bf16 v[172:175], v[40:43], v[76:79], v[172:175]
    ds_read_b64_tr_b16 v[110:111], v13 offset:25952
    v_alignbit_b32 v6, v23, v22, 16
    v_mfma_f32_16x16x32_bf16 v[224:227], v[56:59], v[64:67], v[224:227]
    v_alignbit_b32 v7, v24, v23, 16
    ds_write_b128 v2, v[4:7] offset:4160
    v_mfma_f32_16x16x32_bf16 v[228:231], v[56:59], v[68:71], v[228:231]
    v_alignbit_b32 v20, v29, v28, 16
    v_alignbit_b32 v21, v30, v29, 16
    v_mfma_f32_16x16x32_bf16 v[232:235], v[56:59], v[72:75], v[232:235]
    buffer_load_dwordx4 a[84:87], v10, s[40:43], s71 offen offset:1024 sc1
    v_alignbit_b32 v22, v31, v30, 16
    v_alignbit_b32 v23, v25, v31, 16
    v_mfma_f32_16x16x32_bf16 v[236:239], v[56:59], v[76:79], v[236:239]
    ds_write_b128 v2, v[20:23] offset:5184
    v_mfma_f32_16x16x32_bf16 v[176:179], v[44:47], v[64:67], v[176:179]
    v_and_b32 v4, 15, v1
    v_and_b32 v7, 1, v1
    v_xor_b32 v7, 1, v7
    v_mfma_f32_16x16x32_bf16 v[180:183], v[44:47], v[68:71], v[180:183]
    buffer_load_dwordx4 a[88:91], v10, s[40:43], s71 offen offset:2048 sc1
    v_mul_u32_u24 v7, 4160, v7
    v_sub_u32 v5, 15, v4
    v_lshrrev_b32 v5, 1, v5
    v_mfma_f32_16x16x32_bf16 v[184:187], v[44:47], v[72:75], v[184:187]
    v_lshl_add_u32 v7, v5, 2, v7
    v_lshrrev_b32 v5, 4, v1
    v_lshl_add_u32 v7, v5, 4, v7
    v_mfma_f32_16x16x32_bf16 v[188:191], v[44:47], v[76:79], v[188:191]
    s_mul_i32 s56, s65, 8320
    s_lshl_b32 s57, s64, 8
    s_add_u32 s56, s57, s56
    v_mfma_f32_16x16x32_bf16 v[240:243], v[60:63], v[64:67], v[240:243]
    buffer_load_dwordx4 a[92:95], v10, s[40:43], s71 offen offset:3072 sc1
    s_add_u32 s56, s56, 101376
    v_add_u32 v24, s56, v7
    v_add_u32 v25, 1024, v24
    v_mfma_f32_16x16x32_bf16 v[244:247], v[60:63], v[68:71], v[244:247]
    v_add_u32 v26, 2048, v24
    v_add_u32 v27, 3072, v24
    v_lshlrev_b32 v7, 5, v4
    v_mfma_f32_16x16x32_bf16 v[248:251], v[60:63], v[72:75], v[248:251]
    v_lshl_add_u32 v7, v5, 4, v7
    s_mul_i32 s56, s65, 4608
    s_add_u32 s56, s56, s57
    v_mfma_f32_16x16x32_bf16 v[252:255], v[60:63], v[76:79], v[252:255]
    s_add_u32 s56, s56, 152096
    v_add_u32 v28, s56, v7
    s_waitcnt lgkmcnt(0)
    s_barrier
    v_mfma_f32_16x16x32_bf16 v[128:131], v[80:83], v[112:115], v[128:131]
    ds_read2_b32 v[32:33], v27 offset0:128 offset1:129
    v_mfma_f32_16x16x32_bf16 v[132:135], v[80:83], v[116:119], v[132:135]
    ds_read2_b32 v[34:35], v27 offset0:130 offset1:131
    v_mfma_f32_16x16x32_bf16 v[136:139], v[80:83], v[120:123], v[136:139]
    s_add_u32 s71, s100, 24576
    buffer_load_dwordx4 a[96:99], v10, s[40:43], s71 offen offset:0 sc1
    ds_read_b128 v[36:39], v28 offset:0
    v_mfma_f32_16x16x32_bf16 v[140:143], v[80:83], v[124:127], v[140:143]
    ds_read2_b32 v[40:41], v27 offset0:0 offset1:1
    v_mfma_f32_16x16x32_bf16 v[192:195], v[96:99], v[112:115], v[192:195]
    ds_read2_b32 v[42:43], v27 offset0:2 offset1:3
    v_mfma_f32_16x16x32_bf16 v[196:199], v[96:99], v[116:119], v[196:199]
    buffer_load_dwordx4 a[100:103], v10, s[40:43], s71 offen offset:1024 sc1
    ds_read_b128 v[44:47], v28 offset:512
    v_mfma_f32_16x16x32_bf16 v[200:203], v[96:99], v[120:123], v[200:203]
    ds_read2_b32 v[48:49], v26 offset0:128 offset1:129
    v_mfma_f32_16x16x32_bf16 v[204:207], v[96:99], v[124:127], v[204:207]
    ds_read2_b32 v[50:51], v26 offset0:130 offset1:131
    v_mfma_f32_16x16x32_bf16 v[144:147], v[84:87], v[112:115], v[144:147]
    buffer_load_dwordx4 a[104:107], v10, s[40:43], s71 offen offset:2048 sc1
    ds_read_b128 v[52:55], v28 offset:1024
    v_mfma_f32_16x16x32_bf16 v[148:151], v[84:87], v[116:119], v[148:151]
    ds_read2_b32 v[56:57], v26 offset0:0 offset1:1
    v_mfma_f32_16x16x32_bf16 v[152:155], v[84:87], v[120:123], v[152:155]
    ds_read2_b32 v[58:59], v26 offset0:2 offset1:3
    v_mfma_f32_16x16x32_bf16 v[156:159], v[84:87], v[124:127], v[156:159]
    buffer_load_dwordx4 a[108:111], v10, s[40:43], s71 offen offset:3072 sc1
    ds_read_b128 v[60:63], v28 offset:1536
    v_mfma_f32_16x16x32_bf16 v[208:211], v[100:103], v[112:115], v[208:211]
    ds_read2_b32 v[64:65], v25 offset0:128 offset1:129
    v_mfma_f32_16x16x32_bf16 v[212:215], v[100:103], v[116:119], v[212:215]
    ds_read2_b32 v[66:67], v25 offset0:130 offset1:131
    v_mfma_f32_16x16x32_bf16 v[216:219], v[100:103], v[120:123], v[216:219]
    s_add_u32 s71, s100, 28672
    buffer_load_dwordx4 a[112:115], v10, s[40:43], s71 offen offset:0 sc1
    ds_read_b128 v[68:71], v28 offset:2048
    v_mfma_f32_16x16x32_bf16 v[220:223], v[100:103], v[124:127], v[220:223]
    ds_read2_b32 v[72:73], v25 offset0:0 offset1:1
    v_mfma_f32_16x16x32_bf16 v[160:163], v[88:91], v[112:115], v[160:163]
    ds_read2_b32 v[74:75], v25 offset0:2 offset1:3
    v_mfma_f32_16x16x32_bf16 v[164:167], v[88:91], v[116:119], v[164:167]
    ds_read_b128 v[76:79], v28 offset:2560
    v_mfma_f32_16x16x32_bf16 v[168:171], v[88:91], v[120:123], v[168:171]
    v_mul_f32 v128, v128, v192
    v_mul_f32 v129, v129, v193
    v_mul_f32 v130, v130, v194
    v_mul_f32 v131, v131, v195
    v_mfma_f32_16x16x32_bf16 v[172:175], v[88:91], v[124:127], v[172:175]
    v_mul_f32 v144, v144, v208
    v_mul_f32 v145, v145, v209
    v_mul_f32 v146, v146, v210
    v_mul_f32 v147, v147, v211
    v_mfma_f32_16x16x32_bf16 v[224:227], v[104:107], v[112:115], v[224:227]
    v_cvt_pk_bf16_f32 v192, v128, v129
    v_cvt_pk_bf16_f32 v193, v130, v131
    v_cvt_pk_bf16_f32 v194, v144, v145
    v_cvt_pk_bf16_f32 v195, v146, v147
    v_mfma_f32_16x16x32_bf16 v[228:231], v[104:107], v[116:119], v[228:231]
    buffer_store_dwordx4 v[192:195], v10, s[40:43], s72 offen offset:0 sc1
    v_mul_f32 v132, v132, v196
    v_mul_f32 v133, v133, v197
    v_mfma_f32_16x16x32_bf16 v[232:235], v[104:107], v[120:123], v[232:235]
    v_mul_f32 v134, v134, v198
    v_mul_f32 v135, v135, v199
    v_mul_f32 v148, v148, v212
    v_mul_f32 v149, v149, v213
    v_mfma_f32_16x16x32_bf16 v[236:239], v[104:107], v[124:127], v[236:239]
    v_mul_f32 v150, v150, v214
    v_mul_f32 v151, v151, v215
    v_cvt_pk_bf16_f32 v196, v132, v133
    v_cvt_pk_bf16_f32 v197, v134, v135
    v_mfma_f32_16x16x32_bf16 v[176:179], v[92:95], v[112:115], v[176:179]
    v_cvt_pk_bf16_f32 v198, v148, v149
    v_cvt_pk_bf16_f32 v199, v150, v151
    buffer_store_dwordx4 v[196:199], v10, s[40:43], s72 offen offset:1024 sc1
    v_mfma_f32_16x16x32_bf16 v[180:183], v[92:95], v[116:119], v[180:183]
    v_mul_f32 v136, v136, v200
    v_mul_f32 v137, v137, v201
    v_mul_f32 v138, v138, v202
    v_mul_f32 v139, v139, v203
    v_mfma_f32_16x16x32_bf16 v[184:187], v[92:95], v[120:123], v[184:187]
    v_mul_f32 v152, v152, v216
    v_mul_f32 v153, v153, v217
    v_mul_f32 v154, v154, v218
    v_mul_f32 v155, v155, v219
    v_mfma_f32_16x16x32_bf16 v[188:191], v[92:95], v[124:127], v[188:191]
    v_cvt_pk_bf16_f32 v200, v136, v137
    v_cvt_pk_bf16_f32 v201, v138, v139
    v_cvt_pk_bf16_f32 v202, v152, v153
    v_cvt_pk_bf16_f32 v203, v154, v155
    v_mfma_f32_16x16x32_bf16 v[240:243], v[108:111], v[112:115], v[240:243]
    buffer_store_dwordx4 v[200:203], v10, s[40:43], s72 offen offset:2048 sc1
    v_mul_f32 v140, v140, v204
    v_mul_f32 v141, v141, v205
    v_mfma_f32_16x16x32_bf16 v[244:247], v[108:111], v[116:119], v[244:247]
    v_mul_f32 v142, v142, v206
    v_mul_f32 v143, v143, v207
    v_mul_f32 v156, v156, v220
    v_mul_f32 v157, v157, v221
    v_mfma_f32_16x16x32_bf16 v[248:251], v[108:111], v[120:123], v[248:251]
    v_mul_f32 v158, v158, v222
    v_mul_f32 v159, v159, v223
    v_cvt_pk_bf16_f32 v204, v140, v141
    v_cvt_pk_bf16_f32 v205, v142, v143
    v_mfma_f32_16x16x32_bf16 v[252:255], v[108:111], v[124:127], v[252:255]
    v_cvt_pk_bf16_f32 v206, v156, v157
    v_cvt_pk_bf16_f32 v207, v158, v159
    buffer_store_dwordx4 v[204:207], v10, s[40:43], s72 offen offset:3072 sc1
L_conv:
    ds_read2_b32 v[80:81], v24 offset0:128 offset1:129
    ds_read2_b32 v[82:83], v24 offset0:130 offset1:131
    ds_read_b128 v[84:87], v28 offset:3072
    ds_read2_b32 v[88:89], v24 offset0:0 offset1:1
    ds_read2_b32 v[90:91], v24 offset0:2 offset1:3
    ds_read_b128 v[92:95], v28 offset:3584
    s_waitcnt lgkmcnt(6)
    v_mfma_f32_16x16x32_bf16 a[224:227], v[32:35], v[36:39], 0
    v_mul_f32 v160, v160, v224
    v_mul_f32 v161, v161, v225
    v_mul_f32 v162, v162, v226
    v_mul_f32 v163, v163, v227
    v_mfma_f32_16x16x32_bf16 a[228:231], v[32:35], v[44:47], 0
    v_mul_f32 v176, v176, v240
    v_mul_f32 v177, v177, v241
    v_mul_f32 v178, v178, v242
    v_mfma_f32_16x16x32_bf16 a[228:231], v[40:43], v[36:39], a[228:231]
    v_mul_f32 v179, v179, v243
    v_cvt_pk_bf16_f32 v224, v160, v161
    v_cvt_pk_bf16_f32 v225, v162, v163
    v_mfma_f32_16x16x32_bf16 a[232:235], v[40:43], v[44:47], 0
    v_cvt_pk_bf16_f32 v226, v176, v177
    v_cvt_pk_bf16_f32 v227, v178, v179
    buffer_store_dwordx4 v[224:227], v10, s[40:43], s73 offen offset:0 sc1
    v_mfma_f32_16x16x32_bf16 a[232:235], v[32:35], v[52:55], a[232:235]
    v_mul_f32 v164, v164, v228
    v_mul_f32 v165, v165, v229
    v_mul_f32 v166, v166, v230
    v_mul_f32 v167, v167, v231
    v_mfma_f32_16x16x32_bf16 a[236:239], v[40:43], v[52:55], 0
    v_mul_f32 v180, v180, v244
    v_mul_f32 v181, v181, v245
    v_mul_f32 v182, v182, v246
    v_mfma_f32_16x16x32_bf16 a[232:235], v[48:51], v[36:39], a[232:235]
    v_mul_f32 v183, v183, v247
    v_cvt_pk_bf16_f32 v228, v164, v165
    v_cvt_pk_bf16_f32 v229, v166, v167
    v_mfma_f32_16x16x32_bf16 a[236:239], v[48:51], v[44:47], a[236:239]
    v_cvt_pk_bf16_f32 v230, v180, v181
    v_cvt_pk_bf16_f32 v231, v182, v183
    buffer_store_dwordx4 v[228:231], v10, s[40:43], s73 offen offset:1024 sc1
    v_mfma_f32_16x16x32_bf16 a[240:243], v[48:51], v[52:55], 0
    v_mul_f32 v168, v168, v232
    v_mul_f32 v169, v169, v233
    v_mul_f32 v170, v170, v234
    v_mul_f32 v171, v171, v235
    v_mfma_f32_16x16x32_bf16 a[236:239], v[32:35], v[60:63], a[236:239]
    v_mul_f32 v184, v184, v248
    v_mul_f32 v185, v185, v249
    v_mul_f32 v186, v186, v250
    v_mfma_f32_16x16x32_bf16 a[240:243], v[40:43], v[60:63], a[240:243]
    v_mul_f32 v187, v187, v251
    v_cvt_pk_bf16_f32 v232, v168, v169
    v_cvt_pk_bf16_f32 v233, v170, v171
    v_mfma_f32_16x16x32_bf16 a[244:247], v[48:51], v[60:63], 0
    v_cvt_pk_bf16_f32 v234, v184, v185
    v_cvt_pk_bf16_f32 v235, v186, v187
    buffer_store_dwordx4 v[232:235], v10, s[40:43], s73 offen offset:2048 sc1
    v_mfma_f32_16x16x32_bf16 a[236:239], v[56:59], v[36:39], a[236:239]
    v_mul_f32 v172, v172, v236
    v_mul_f32 v173, v173, v237
    v_mul_f32 v174, v174, v238
    v_mul_f32 v175, v175, v239
    s_waitcnt lgkmcnt(0)
    v_mfma_f32_16x16x32_bf16 a[240:243], v[56:59], v[44:47], a[240:243]
    v_mul_f32 v188, v188, v252
    v_mul_f32 v189, v189, v253
    v_mul_f32 v190, v190, v254
    v_mfma_f32_16x16x32_bf16 a[244:247], v[56:59], v[52:55], a[244:247]
    v_mul_f32 v191, v191, v255
    v_cvt_pk_bf16_f32 v236, v172, v173
    v_cvt_pk_bf16_f32 v237, v174, v175
    ds_read2_b32 v[96:97], v27 offset0:144 offset1:145
    ds_read2_b32 v[98:99], v27 offset0:146 offset1:147
    v_mfma_f32_16x16x32_bf16 a[248:251], v[56:59], v[60:63], 0
    v_cvt_pk_bf16_f32 v238, v188, v189
    v_cvt_pk_bf16_f32 v239, v190, v191
    buffer_store_dwordx4 v[236:239], v10, s[40:43], s73 offen offset:3072 sc1
    ds_read_b128 v[100:103], v28 offset:64
    v_mfma_f32_16x16x32_bf16 a[240:243], v[32:35], v[68:71], a[240:243]
    ds_read2_b32 v[104:105], v27 offset0:16 offset1:17
    v_mfma_f32_16x16x32_bf16 a[244:247], v[40:43], v[68:71], a[244:247]
    ds_read2_b32 v[106:107], v27 offset0:18 offset1:19
    v_mfma_f32_16x16x32_bf16 a[248:251], v[48:51], v[68:71], a[248:251]
    ds_read_b128 v[108:111], v28 offset:576
    buffer_load_dwordx4 a[116:119], v10, s[40:43], s71 offen offset:1024 sc1
    v_mfma_f32_16x16x32_bf16 a[252:255], v[56:59], v[68:71], 0
    ds_read2_b32 v[112:113], v26 offset0:144 offset1:145
    ds_read2_b32 v[114:115], v26 offset0:146 offset1:147
    v_mfma_f32_16x16x32_bf16 a[240:243], v[64:67], v[36:39], a[240:243]
    ds_read_b128 v[116:119], v28 offset:1088
    v_mfma_f32_16x16x32_bf16 a[244:247], v[64:67], v[44:47], a[244:247]
    ds_read2_b32 v[120:121], v26 offset0:16 offset1:17
    v_mfma_f32_16x16x32_bf16 a[248:251], v[64:67], v[52:55], a[248:251]
    ds_read2_b32 v[122:123], v26 offset0:18 offset1:19
    v_mfma_f32_16x16x32_bf16 a[252:255], v[64:67], v[60:63], a[252:255]
    ds_read_b128 v[124:127], v28 offset:1600
    v_mfma_f32_16x16x32_bf16 a[244:247], v[32:35], v[76:79], a[244:247]
    ds_read2_b32 v[128:129], v25 offset0:144 offset1:145
    ds_read2_b32 v[130:131], v25 offset0:146 offset1:147
    v_mfma_f32_16x16x32_bf16 a[248:251], v[40:43], v[76:79], a[248:251]
    ds_read_b128 v[132:135], v28 offset:2112
    v_mfma_f32_16x16x32_bf16 a[252:255], v[48:51], v[76:79], a[252:255]
    ds_read2_b32 v[136:137], v25 offset0:16 offset1:17
    v_mfma_f32_16x16x32_bf16 a[244:247], v[72:75], v[36:39], a[244:247]
    ds_read2_b32 v[138:139], v25 offset0:18 offset1:19
    buffer_load_dwordx4 a[120:123], v10, s[40:43], s71 offen offset:2048 sc1
    v_mfma_f32_16x16x32_bf16 a[248:251], v[72:75], v[44:47], a[248:251]
    ds_read_b128 v[140:143], v28 offset:2624
    v_mfma_f32_16x16x32_bf16 a[252:255], v[72:75], v[52:55], a[252:255]
    ds_read2_b32 v[144:145], v24 offset0:144 offset1:145
    ds_read2_b32 v[146:147], v24 offset0:146 offset1:147
    v_mfma_f32_16x16x32_bf16 a[248:251], v[32:35], v[84:87], a[248:251]
    ds_read_b128 v[148:151], v28 offset:3136
    v_mfma_f32_16x16x32_bf16 a[252:255], v[40:43], v[84:87], a[252:255]
    ds_read2_b32 v[152:153], v24 offset0:16 offset1:17
    v_mfma_f32_16x16x32_bf16 a[248:251], v[80:83], v[36:39], a[248:251]
    ds_read2_b32 v[154:155], v24 offset0:18 offset1:19
    v_mfma_f32_16x16x32_bf16 a[252:255], v[80:83], v[44:47], a[252:255]
    ds_read_b128 v[156:159], v28 offset:3648
    v_mfma_f32_16x16x32_bf16 a[252:255], v[32:35], v[92:95], a[252:255]
    v_mfma_f32_16x16x32_bf16 a[252:255], v[88:91], v[36:39], a[252:255]
    s_waitcnt lgkmcnt(0)
    v_mfma_f32_16x16x32_bf16 a[224:227], v[96:99], v[100:103], a[224:227]
    ds_read2_b32 v[32:33], v27 offset0:160 offset1:161
    buffer_load_dwordx4 a[124:127], v10, s[40:43], s71 offen offset:3072 sc1
    v_mfma_f32_16x16x32_bf16 a[228:231], v[96:99], v[108:111], a[228:231]
    ds_read2_b32 v[34:35], v27 offset0:162 offset1:163
    v_mfma_f32_16x16x32_bf16 a[228:231], v[104:107], v[100:103], a[228:231]
    ds_read_b128 v[36:39], v28 offset:128
    v_mfma_f32_16x16x32_bf16 a[232:235], v[104:107], v[108:111], a[232:235]
    ds_read2_b32 v[40:41], v27 offset0:32 offset1:33
    v_mfma_f32_16x16x32_bf16 a[232:235], v[96:99], v[116:119], a[232:235]
    ds_read2_b32 v[42:43], v27 offset0:34 offset1:35
    v_mfma_f32_16x16x32_bf16 a[236:239], v[104:107], v[116:119], a[236:239]
    ds_read_b128 v[44:47], v28 offset:640
    s_add_u32 s71, s100, 32768
    buffer_load_dwordx4 a[128:131], v10, s[40:43], s71 offen offset:0 sc1
    v_mfma_f32_16x16x32_bf16 a[232:235], v[112:115], v[100:103], a[232:235]
    ds_read2_b32 v[48:49], v26 offset0:160 offset1:161
    v_mfma_f32_16x16x32_bf16 a[236:239], v[112:115], v[108:111], a[236:239]
    ds_read2_b32 v[50:51], v26 offset0:162 offset1:163
    v_mfma_f32_16x16x32_bf16 a[240:243], v[112:115], v[116:119], a[240:243]
    ds_read_b128 v[52:55], v28 offset:1152
    v_mfma_f32_16x16x32_bf16 a[236:239], v[96:99], v[124:127], a[236:239]
    ds_read2_b32 v[56:57], v26 offset0:32 offset1:33
    v_mfma_f32_16x16x32_bf16 a[240:243], v[104:107], v[124:127], a[240:243]
    ds_read2_b32 v[58:59], v26 offset0:34 offset1:35
    buffer_load_dwordx4 a[132:135], v10, s[40:43], s71 offen offset:1024 sc1
    v_mfma_f32_16x16x32_bf16 a[244:247], v[112:115], v[124:127], a[244:247]
    ds_read_b128 v[60:63], v28 offset:1664
    v_mfma_f32_16x16x32_bf16 a[236:239], v[120:123], v[100:103], a[236:239]
    ds_read2_b32 v[64:65], v25 offset0:160 offset1:161
    v_mfma_f32_16x16x32_bf16 a[240:243], v[120:123], v[108:111], a[240:243]
    ds_read2_b32 v[66:67], v25 offset0:162 offset1:163
    v_mfma_f32_16x16x32_bf16 a[244:247], v[120:123], v[116:119], a[244:247]
    ds_read_b128 v[68:71], v28 offset:2176
    v_mfma_f32_16x16x32_bf16 a[248:251], v[120:123], v[124:127], a[248:251]
    ds_read2_b32 v[72:73], v25 offset0:32 offset1:33
    buffer_load_dwordx4 a[136:139], v10, s[40:43], s71 offen offset:2048 sc1
    v_mfma_f32_16x16x32_bf16 a[240:243], v[96:99], v[132:135], a[240:243]
    ds_read2_b32 v[74:75], v25 offset0:34 offset1:35
    v_mfma_f32_16x16x32_bf16 a[244:247], v[104:107], v[132:135], a[244:247]
    ds_read_b128 v[76:79], v28 offset:2688
    v_mfma_f32_16x16x32_bf16 a[248:251], v[112:115], v[132:135], a[248:251]
    ds_read2_b32 v[80:81], v24 offset0:160 offset1:161
    v_mfma_f32_16x16x32_bf16 a[252:255], v[120:123], v[132:135], a[252:255]
    ds_read2_b32 v[82:83], v24 offset0:162 offset1:163
    v_mfma_f32_16x16x32_bf16 a[240:243], v[128:131], v[100:103], a[240:243]
    ds_read_b128 v[84:87], v28 offset:3200
    buffer_load_dwordx4 a[140:143], v10, s[40:43], s71 offen offset:3072 sc1
    v_mfma_f32_16x16x32_bf16 a[244:247], v[128:131], v[108:111], a[244:247]
    ds_read2_b32 v[88:89], v24 offset0:32 offset1:33
    v_mfma_f32_16x16x32_bf16 a[248:251], v[128:131], v[116:119], a[248:251]
    ds_read2_b32 v[90:91], v24 offset0:34 offset1:35
    v_mfma_f32_16x16x32_bf16 a[252:255], v[128:131], v[124:127], a[252:255]
    ds_read_b128 v[92:95], v28 offset:3712
    v_mfma_f32_16x16x32_bf16 a[244:247], v[96:99], v[140:143], a[244:247]
    v_min_u32 v2, 6, v1
    s_lshl_b32 s56, s70, 5
    v_mfma_f32_16x16x32_bf16 a[248:251], v[104:107], v[140:143], a[248:251]
    s_add_u32 s71, s100, 36864
    buffer_load_dwordx4 a[144:147], v10, s[40:43], s71 offen offset:0 sc1
    s_mul_i32 s57, s3, 7
    s_add_u32 s56, s56, s57
    v_mfma_f32_16x16x32_bf16 a[252:255], v[112:115], v[140:143], a[252:255]
    v_add_lshl_u32 v8, v2, s56, 7
    v_add_u32 v8, 131072, v8
    v_mfma_f32_16x16x32_bf16 a[244:247], v[136:139], v[100:103], a[244:247]
    s_add_u32 s56, s3, 0
    s_and_b32 s56, s56, 3
    v_mfma_f32_16x16x32_bf16 a[248:251], v[136:139], v[108:111], a[248:251]
    s_lshl_b32 s56, s56, 10
    v_add_u32 v12, s56, v10
    v_mfma_f32_16x16x32_bf16 a[252:255], v[136:139], v[116:119], a[252:255]
    s_add_u32 s56, s3, 1
    v_mfma_f32_16x16x32_bf16 a[248:251], v[96:99], v[148:151], a[248:251]
    buffer_load_dwordx4 a[148:151], v10, s[40:43], s71 offen offset:1024 sc1
    s_and_b32 s56, s56, 3
    s_lshl_b32 s56, s56, 10
    v_mfma_f32_16x16x32_bf16 a[252:255], v[104:107], v[148:151], a[252:255]
    v_add_u32 v13, s56, v10
    s_add_u32 s56, s3, 2
    v_mfma_f32_16x16x32_bf16 a[248:251], v[144:147], v[100:103], a[248:251]
    s_and_b32 s56, s56, 3
    s_lshl_b32 s56, s56, 10
    v_mfma_f32_16x16x32_bf16 a[252:255], v[144:147], v[108:111], a[252:255]
    v_add_u32 v14, s56, v10
    s_add_u32 s56, s3, 3
    v_mfma_f32_16x16x32_bf16 a[252:255], v[96:99], v[156:159], a[252:255]
    s_and_b32 s56, s56, 3
    s_lshl_b32 s56, s56, 10
    v_mfma_f32_16x16x32_bf16 a[252:255], v[152:155], v[100:103], a[252:255]
    v_add_u32 v15, s56, v10
    s_waitcnt lgkmcnt(0)
    v_mfma_f32_16x16x32_bf16 a[224:227], v[32:35], v[36:39], a[224:227]
    ds_read2_b32 v[96:97], v27 offset0:176 offset1:177
    buffer_load_dwordx4 a[152:155], v10, s[40:43], s71 offen offset:2048 sc1
    s_waitcnt vmcnt(10)
    s_mov_b64 exec, 1
    buffer_store_dwordx2 v[18:19], v9, s[40:43], s68 offen sc1
    s_mov_b64 exec, -1
    v_mfma_f32_16x16x32_bf16 a[228:231], v[32:35], v[44:47], a[228:231]
    ds_read2_b32 v[98:99], v27 offset0:178 offset1:179
    v_mfma_f32_16x16x32_bf16 a[228:231], v[40:43], v[36:39], a[228:231]
    ds_read_b128 v[100:103], v28 offset:192
    v_mfma_f32_16x16x32_bf16 a[232:235], v[40:43], v[44:47], a[232:235]
    ds_read2_b32 v[104:105], v27 offset0:48 offset1:49
    v_mfma_f32_16x16x32_bf16 a[232:235], v[32:35], v[52:55], a[232:235]
    ds_read2_b32 v[106:107], v27 offset0:50 offset1:51
    buffer_load_dwordx4 a[156:159], v10, s[40:43], s71 offen offset:3072 sc1
    s_lshl_b32 s66, s70, 3
    v_mfma_f32_16x16x32_bf16 a[236:239], v[40:43], v[52:55], a[236:239]
    ds_read_b128 v[108:111], v28 offset:704
    v_mfma_f32_16x16x32_bf16 a[232:235], v[48:51], v[36:39], a[232:235]
    ds_read2_b32 v[112:113], v26 offset0:176 offset1:177
    s_add_u32 s66, s66, s69
    v_mfma_f32_16x16x32_bf16 a[236:239], v[48:51], v[44:47], a[236:239]
    ds_read2_b32 v[114:115], v26 offset0:178 offset1:179
    v_mfma_f32_16x16x32_bf16 a[240:243], v[48:51], v[52:55], a[240:243]
    ds_read_b128 v[116:119], v28 offset:1216
    s_lshl_b32 s66, s66, 2
    v_mfma_f32_16x16x32_bf16 a[236:239], v[32:35], v[60:63], a[236:239]
    ds_read2_b32 v[120:121], v26 offset0:48 offset1:49
    s_add_u32 s71, s100, 40960
    buffer_load_dwordx4 a[160:163], v10, s[40:43], s71 offen offset:0 sc1
    v_mfma_f32_16x16x32_bf16 a[240:243], v[40:43], v[60:63], a[240:243]
    ds_read2_b32 v[122:123], v26 offset0:50 offset1:51
    s_add_u32 s66, s66, s3
    v_mfma_f32_16x16x32_bf16 a[244:247], v[48:51], v[60:63], a[244:247]
    ds_read_b128 v[124:127], v28 offset:1728
    v_mfma_f32_16x16x32_bf16 a[236:239], v[56:59], v[36:39], a[236:239]
    ds_read2_b32 v[128:129], v25 offset0:176 offset1:177
    s_lshl_b32 s67, s66, 4
    v_mfma_f32_16x16x32_bf16 a[240:243], v[56:59], v[44:47], a[240:243]
    ds_read2_b32 v[130:131], v25 offset0:178 offset1:179
    buffer_load_dwordx4 a[164:167], v10, s[40:43], s71 offen offset:1024 sc1
    v_mfma_f32_16x16x32_bf16 a[244:247], v[56:59], v[52:55], a[244:247]
    ds_read_b128 v[132:135], v28 offset:2240
    s_add_u32 s67, s67, 49152
    v_mfma_f32_16x16x32_bf16 a[248:251], v[56:59], v[60:63], a[248:251]
    ds_read2_b32 v[136:137], v25 offset0:48 offset1:49
    v_mfma_f32_16x16x32_bf16 a[240:243], v[32:35], v[68:71], a[240:243]
    ds_read2_b32 v[138:139], v25 offset0:50 offset1:51
    s_lshl_b32 s66, s66, 11
    v_mfma_f32_16x16x32_bf16 a[244:247], v[40:43], v[68:71], a[244:247]
    ds_read_b128 v[140:143], v28 offset:2752
    v_mfma_f32_16x16x32_bf16 a[248:251], v[48:51], v[68:71], a[248:251]
    ds_read2_b32 v[144:145], v24 offset0:176 offset1:177
    buffer_load_dwordx4 a[168:171], v10, s[40:43], s71 offen offset:2048 sc1
    buffer_load_dwordx4 v[168:171], v10, s[8:11], s66 offen
    v_mfma_f32_16x16x32_bf16 a[252:255], v[56:59], v[68:71], a[252:255]
    ds_read2_b32 v[146:147], v24 offset0:178 offset1:179
    v_mfma_f32_16x16x32_bf16 a[240:243], v[64:67], v[36:39], a[240:243]
    ds_read_b128 v[148:151], v28 offset:3264
    buffer_load_dwordx4 v[172:175], v10, s[8:11], s66 offen offset:1024
    v_mfma_f32_16x16x32_bf16 a[244:247], v[64:67], v[44:47], a[244:247]
    ds_read2_b32 v[152:153], v24 offset0:48 offset1:49
    v_mfma_f32_16x16x32_bf16 a[248:251], v[64:67], v[52:55], a[248:251]
    ds_read2_b32 v[154:155], v24 offset0:50 offset1:51
    buffer_load_dwordx4 a[172:175], v10, s[40:43], s71 offen offset:3072 sc1
    global_load_dwordx4 v[176:179], v10, s[52:53]
    v_mfma_f32_16x16x32_bf16 a[252:255], v[64:67], v[60:63], a[252:255]
    ds_read_b128 v[156:159], v28 offset:3776
    v_mfma_f32_16x16x32_bf16 a[244:247], v[32:35], v[76:79], a[244:247]
    v_lshrrev_b32 v2, 4, v1
    v_lshl_add_u32 v2, v2, 6, v10
    v_mfma_f32_16x16x32_bf16 a[248:251], v[40:43], v[76:79], a[248:251]
    s_mul_i32 s56, s3, 10240
    v_add_u32 v2, s56, v2
    v_mfma_f32_16x16x32_bf16 a[252:255], v[48:51], v[76:79], a[252:255]
    v_and_b32 v3, 3, v1
    v_mul_u32_u24 v3, 320, v3
    v_mfma_f32_16x16x32_bf16 a[244:247], v[72:75], v[36:39], a[244:247]
    s_add_u32 s71, s100, 45056
    buffer_load_dwordx4 a[176:179], v10, s[40:43], s71 offen offset:0 sc1
    v_lshrrev_b32 v4, 2, v1
    v_lshl_add_u32 v3, v4, 4, v3
    v_mfma_f32_16x16x32_bf16 a[248:251], v[72:75], v[44:47], a[248:251]
    s_mul_i32 s56, s3, 2560
    v_add_u32 v3, s56, v3
    v_mfma_f32_16x16x32_bf16 a[252:255], v[72:75], v[52:55], a[252:255]
    v_lshlrev_b32 v4, 3, v1
    s_lshl_b32 s56, s3, 10
    v_mfma_f32_16x16x32_bf16 a[248:251], v[32:35], v[84:87], a[248:251]
    s_sub_u32 s56, 104952, s56
    v_sub_u32 v4, s56, v4
    v_mfma_f32_16x16x32_bf16 a[252:255], v[40:43], v[84:87], a[252:255]
    buffer_load_dwordx4 a[180:183], v10, s[40:43], s71 offen offset:1024 sc1
    s_lshl_b32 s72, s60, 16
    s_and_b32 s73, s60, 0xffff0000
    v_mfma_f32_16x16x32_bf16 a[248:251], v[80:83], v[36:39], a[248:251]
    s_lshl_b32 s56, s58, 13
    s_lshl_b32 s57, s3, 11
    v_mfma_f32_16x16x32_bf16 a[252:255], v[80:83], v[44:47], a[252:255]
    s_add_u32 s56, s56, s57
    s_add_u32 s63, s56, 4194304
    v_mfma_f32_16x16x32_bf16 a[252:255], v[32:35], v[92:95], a[252:255]
    s_lshl_b32 s75, s3, 8
    s_add_u32 s75, s75, s58
    v_mfma_f32_16x16x32_bf16 a[252:255], v[88:91], v[36:39], a[252:255]
    s_lshl_b32 s75, s75, 7
    s_add_u32 s75, s75, 262144
    s_waitcnt lgkmcnt(0)
    v_mfma_f32_16x16x32_bf16 a[224:227], v[96:99], v[100:103], a[224:227]
    buffer_load_dwordx4 a[184:187], v10, s[40:43], s71 offen offset:2048 sc1
    ds_read_b64 v[208:209], v4 offset:512
    v_mfma_f32_16x16x32_bf16 a[228:231], v[96:99], v[108:111], a[228:231]
    ds_read_b64 v[210:211], v4 offset:8832
    v_mfma_f32_16x16x32_bf16 a[228:231], v[104:107], v[100:103], a[228:231]
    ds_read_b64 v[212:213], v4 offset:0
    v_mfma_f32_16x16x32_bf16 a[232:235], v[104:107], v[108:111], a[232:235]
    buffer_load_dwordx4 a[188:191], v10, s[40:43], s71 offen offset:3072 sc1
    ds_read_b64 v[214:215], v4 offset:8320
    v_mfma_f32_16x16x32_bf16 a[232:235], v[96:99], v[116:119], a[232:235]
    v_mfma_f32_16x16x32_bf16 a[236:239], v[104:107], v[116:119], a[236:239]
    v_mfma_f32_16x16x32_bf16 a[232:235], v[112:115], v[100:103], a[232:235]
    s_add_u32 s71, s100, 49152
    buffer_load_dwordx4 a[192:195], v10, s[40:43], s71 offen offset:0 sc1
    v_mfma_f32_16x16x32_bf16 a[236:239], v[112:115], v[108:111], a[236:239]
    v_mfma_f32_16x16x32_bf16 a[240:243], v[112:115], v[116:119], a[240:243]
    v_mfma_f32_16x16x32_bf16 a[236:239], v[96:99], v[124:127], a[236:239]
    v_mfma_f32_16x16x32_bf16 a[240:243], v[104:107], v[124:127], a[240:243]
    buffer_load_dwordx4 a[196:199], v10, s[40:43], s71 offen offset:1024 sc1
    s_waitcnt lgkmcnt(0)
    v_and_b32 v192, s61, v209
    v_mfma_f32_16x16x32_bf16 a[244:247], v[112:115], v[124:127], a[244:247]
    v_lshlrev_b32 v193, 16, v209
    v_mfma_f32_16x16x32_bf16 a[236:239], v[120:123], v[100:103], a[236:239]
    v_and_b32 v194, s61, v208
    v_lshlrev_b32 v195, 16, v208
    v_mfma_f32_16x16x32_bf16 a[240:243], v[120:123], v[108:111], a[240:243]
    buffer_load_dwordx4 a[200:203], v10, s[40:43], s71 offen offset:2048 sc1
    v_mul_f32 v192, s72, v192
    v_mfma_f32_16x16x32_bf16 a[244:247], v[120:123], v[116:119], a[244:247]
    v_mul_f32 v193, s72, v193
    v_mfma_f32_16x16x32_bf16 a[248:251], v[120:123], v[124:127], a[248:251]
    v_mul_f32 v194, s72, v194
    v_mul_f32 v195, s72, v195
    v_mfma_f32_16x16x32_bf16 a[240:243], v[96:99], v[132:135], a[240:243]
    v_and_b32 v196, s61, v211
    v_mfma_f32_16x16x32_bf16 a[244:247], v[104:107], v[132:135], a[244:247]
    buffer_load_dwordx4 a[204:207], v10, s[40:43], s71 offen offset:3072 sc1
    v_lshlrev_b32 v197, 16, v211
    v_mfma_f32_16x16x32_bf16 a[248:251], v[112:115], v[132:135], a[248:251]
    v_and_b32 v198, s61, v210
    v_lshlrev_b32 v199, 16, v210
    v_mfma_f32_16x16x32_bf16 a[252:255], v[120:123], v[132:135], a[252:255]
    v_mul_f32 v196, s73, v196
    v_mfma_f32_16x16x32_bf16 a[240:243], v[128:131], v[100:103], a[240:243]
    s_add_u32 s71, s100, 53248
    buffer_load_dwordx4 a[208:211], v10, s[40:43], s71 offen offset:0 sc1
    v_mul_f32 v197, s73, v197
    v_mul_f32 v198, s73, v198
    v_mfma_f32_16x16x32_bf16 a[244:247], v[128:131], v[108:111], a[244:247]
    v_mul_f32 v199, s73, v199
    v_mfma_f32_16x16x32_bf16 a[248:251], v[128:131], v[116:119], a[248:251]
    v_and_b32 v200, s61, v213
    v_mfma_f32_16x16x32_bf16 a[252:255], v[128:131], v[124:127], a[252:255]
    buffer_load_dwordx4 a[212:215], v10, s[40:43], s71 offen offset:1024 sc1
    v_lshlrev_b32 v201, 16, v213
    v_and_b32 v202, s61, v212
    v_mfma_f32_16x16x32_bf16 a[244:247], v[96:99], v[140:143], a[244:247]
    v_lshlrev_b32 v203, 16, v212
    v_mfma_f32_16x16x32_bf16 a[248:251], v[104:107], v[140:143], a[248:251]
    v_mul_f32 v200, s72, v200
    v_mfma_f32_16x16x32_bf16 a[252:255], v[112:115], v[140:143], a[252:255]
    v_mul_f32 v201, s72, v201
    v_mul_f32 v202, s72, v202
    v_mfma_f32_16x16x32_bf16 a[244:247], v[136:139], v[100:103], a[244:247]
    buffer_load_dwordx4 a[216:219], v10, s[40:43], s71 offen offset:2048 sc1
    v_mul_f32 v203, s72, v203
    v_mfma_f32_16x16x32_bf16 a[248:251], v[136:139], v[108:111], a[248:251]
    v_and_b32 v204, s61, v215
    v_lshlrev_b32 v205, 16, v215
    v_mfma_f32_16x16x32_bf16 a[252:255], v[136:139], v[116:119], a[252:255]
    v_and_b32 v206, s61, v214
    v_mfma_f32_16x16x32_bf16 a[248:251], v[96:99], v[148:151], a[248:251]
    buffer_load_dwordx4 a[220:223], v10, s[40:43], s71 offen offset:3072 sc1
    v_lshlrev_b32 v207, 16, v214
    v_mfma_f32_16x16x32_bf16 a[252:255], v[104:107], v[148:151], a[252:255]
    v_mul_f32 v204, s73, v204
    v_mul_f32 v205, s73, v205
    v_mfma_f32_16x16x32_bf16 a[248:251], v[144:147], v[100:103], a[248:251]
    v_mul_f32 v206, s73, v206
    v_mfma_f32_16x16x32_bf16 a[252:255], v[144:147], v[108:111], a[252:255]
    v_mul_f32 v207, s73, v207
    v_mfma_f32_16x16x32_bf16 a[252:255], v[96:99], v[156:159], a[252:255]
    s_mul_i32 s71, s70, 56
    s_mul_i32 s56, s3, 14
    s_add_u32 s71, s71, s56
    s_lshl_b32 s71, s71, 12
    s_add_u32 s100, s71, 16777216
    v_mfma_f32_16x16x32_bf16 a[252:255], v[152:155], v[100:103], a[252:255]
    buffer_load_dwordx2 v[6:7], v8, s[40:43], 0 offen sc1
    s_nop 6
    ds_write_b128 v2, a[224:227] offset:0
    ds_write_b128 v2, a[228:231] offset:1280
    ds_write_b128 v2, a[232:235] offset:2560
    ds_write_b128 v2, a[236:239] offset:3840
    ds_write_b128 v2, a[240:243] offset:5120
    ds_write_b128 v2, a[244:247] offset:6400
    ds_write_b128 v2, a[248:251] offset:7680
    ds_write_b128 v2, a[252:255] offset:8960
    s_waitcnt vmcnt(13)
    s_mov_b32 s66, 0x3f803f80
    v_lshlrev_b32 v180, 16, v176
    v_and_b32 v181, s61, v176
    v_lshlrev_b32 v182, 16, v168
    v_and_b32 v183, s61, v168
    v_lshlrev_b32 v184, 16, v172
    v_and_b32 v185, s61, v172
    v_pk_mul_f32 v[182:183], v[182:183], v[180:181]
    v_pk_mul_f32 v[184:185], v[184:185], v[180:181]
    v_cvt_pk_bf16_f32 v182, v182, v183
    v_cvt_pk_bf16_f32 v184, v184, v185
    v_dot2_f32_bf16 v186, v182, s66, 0
    v_dot2_f32_bf16 v187, v184, s66, 0
    v_lshlrev_b32 v180, 16, v177
    v_and_b32 v181, s61, v177
    v_lshlrev_b32 v182, 16, v169
    v_and_b32 v183, s61, v169
    v_lshlrev_b32 v184, 16, v173
    v_and_b32 v185, s61, v173
    v_pk_mul_f32 v[182:183], v[182:183], v[180:181]
    v_pk_mul_f32 v[184:185], v[184:185], v[180:181]
    v_cvt_pk_bf16_f32 v182, v182, v183
    v_cvt_pk_bf16_f32 v184, v184, v185
    v_dot2_f32_bf16 v186, v182, s66, v186
    v_dot2_f32_bf16 v187, v184, s66, v187
    v_lshlrev_b32 v180, 16, v178
    s_waitcnt lgkmcnt(0)
    s_barrier
    ds_read_b128 v[112:115], v3 offset:0
    ds_read_b128 v[116:119], v3 offset:10240
    ds_read_b128 v[120:123], v3 offset:20480
    ds_read_b128 v[124:127], v3 offset:30720
    ds_read_b128 v[128:131], v3 offset:1280
    ds_read_b128 v[132:135], v3 offset:11520
    ds_read_b128 v[136:139], v3 offset:21760
    ds_read_b128 v[140:143], v3 offset:32000
    v_and_b32 v181, s61, v178
    v_lshlrev_b32 v182, 16, v170
    v_and_b32 v183, s61, v170
    v_lshlrev_b32 v184, 16, v174
    v_and_b32 v185, s61, v174
    v_pk_mul_f32 v[182:183], v[182:183], v[180:181]
    v_pk_mul_f32 v[184:185], v[184:185], v[180:181]
    v_cvt_pk_bf16_f32 v182, v182, v183
    v_cvt_pk_bf16_f32 v184, v184, v185
    v_dot2_f32_bf16 v186, v182, s66, v186
    v_dot2_f32_bf16 v187, v184, s66, v187
    v_lshlrev_b32 v180, 16, v179
    v_and_b32 v181, s61, v179
    v_lshlrev_b32 v182, 16, v171
    v_and_b32 v183, s61, v171
    v_lshlrev_b32 v184, 16, v175
    v_and_b32 v185, s61, v175
    v_pk_mul_f32 v[182:183], v[182:183], v[180:181]
    v_pk_mul_f32 v[184:185], v[184:185], v[180:181]
    v_cvt_pk_bf16_f32 v182, v182, v183
    v_cvt_pk_bf16_f32 v184, v184, v185
    v_dot2_f32_bf16 v186, v182, s66, v186
    v_dot2_f32_bf16 v187, v184, s66, v187
    s_nop 2
    s_waitcnt lgkmcnt(4)
    v_pk_add_f32 v[112:113], v[112:113], v[116:117]
    v_pk_add_f32 v[114:115], v[114:115], v[118:119]
    v_pk_add_f32 v[112:113], v[112:113], v[192:193]
    v_pk_add_f32 v[114:115], v[114:115], v[194:195]
    v_pk_add_f32 v[120:121], v[120:121], v[124:125]
    v_pk_add_f32 v[122:123], v[122:123], v[126:127]
    v_pk_add_f32 v[120:121], v[120:121], v[196:197]
    v_pk_add_f32 v[122:123], v[122:123], v[198:199]
    v_cvt_pk_bf16_f32 v20, v112, v120
    v_cvt_pk_bf16_f32 v21, v113, v121
    v_cvt_pk_bf16_f32 v22, v114, v122
    v_cvt_pk_bf16_f32 v23, v115, v123
    s_waitcnt lgkmcnt(0)
    v_pk_add_f32 v[128:129], v[128:129], v[132:133]
    v_pk_add_f32 v[130:131], v[130:131], v[134:135]
    v_pk_add_f32 v[128:129], v[128:129], v[200:201]
    v_pk_add_f32 v[130:131], v[130:131], v[202:203]
    v_pk_add_f32 v[136:137], v[136:137], v[140:141]
    v_pk_add_f32 v[138:139], v[138:139], v[142:143]
    v_pk_add_f32 v[136:137], v[136:137], v[204:205]
    v_pk_add_f32 v[138:139], v[138:139], v[206:207]
    v_cvt_pk_bf16_f32 v24, v128, v136
    v_cvt_pk_bf16_f32 v25, v129, v137
    v_cvt_pk_bf16_f32 v26, v130, v138
    v_cvt_pk_bf16_f32 v27, v131, v139
    buffer_store_dwordx4 v[20:23], v10, s[40:43], s63 offen offset:0 sc1
    buffer_store_dwordx4 v[24:27], v10, s[40:43], s63 offen offset:1024 sc1
    s_waitcnt vmcnt(2)
    v_cmp_ne_u64 vcc, s[54:55], v[6:7]
    s_mov_b32 s56, 0
    s_cmp_eq_u64 vcc, 0
    s_cbranch_scc1 L_ok_pl_3
L_re_pl_3:
    s_sleep 4
    buffer_load_dwordx2 v[6:7], v8, s[40:43], 0 offen sc1
    s_waitcnt vmcnt(0)
    v_cmp_ne_u64 vcc, s[54:55], v[6:7]
    s_add_u32 s56, s56, 1
    s_cmp_eq_u64 vcc, 0
    s_cbranch_scc1 L_ok_pl_3
    s_cmp_lt_u32 s56, 200000
    s_cbranch_scc1 L_re_pl_3
L_ok_pl_3:
    s_add_u32 s71, s100, 0
    buffer_load_dwordx4 v[32:35], v12, s[40:43], s71 offen sc1
    buffer_load_dwordx4 v[36:39], v13, s[40:43], s71 offen sc1
    buffer_load_dwordx4 v[40:43], v14, s[40:43], s71 offen sc1
    buffer_load_dwordx4 v[44:47], v15, s[40:43], s71 offen sc1
    s_add_u32 s71, s100, 4096
    buffer_load_dwordx4 v[48:51], v12, s[40:43], s71 offen sc1
    buffer_load_dwordx4 v[52:55], v13, s[40:43], s71 offen sc1
    buffer_load_dwordx4 v[56:59], v14, s[40:43], s71 offen sc1
    buffer_load_dwordx4 v[60:63], v15, s[40:43], s71 offen sc1
    v_add_f32_dpp v186, v186, v186 row_shr:1 row_mask:0xf bank_mask:0xf bound_ctrl:0
    v_add_f32_dpp v187, v187, v187 row_shr:1 row_mask:0xf bank_mask:0xf bound_ctrl:0
    s_nop 0
    v_add_f32_dpp v186, v186, v186 row_shr:2 row_mask:0xf bank_mask:0xf bound_ctrl:0
    v_add_f32_dpp v187, v187, v187 row_shr:2 row_mask:0xf bank_mask:0xf bound_ctrl:0
    s_nop 0
    v_add_f32_dpp v186, v186, v186 row_shr:4 row_mask:0xf bank_mask:0xf bound_ctrl:0
    v_add_f32_dpp v187, v187, v187 row_shr:4 row_mask:0xf bank_mask:0xf bound_ctrl:0
    s_nop 0
    v_add_f32_dpp v186, v186, v186 row_shr:8 row_mask:0xf bank_mask:0xf bound_ctrl:0
    v_add_f32_dpp v187, v187, v187 row_shr:8 row_mask:0xf bank_mask:0xf bound_ctrl:0
    s_nop 0
    v_add_f32_dpp v186, v186, v186 row_bcast:15 row_mask:0xa bank_mask:0xf
    v_add_f32_dpp v187, v187, v187 row_bcast:15 row_mask:0xa bank_mask:0xf
    s_nop 0
    v_add_f32_dpp v186, v186, v186 row_bcast:31 row_mask:0xc bank_mask:0xf
    v_add_f32_dpp v187, v187, v187 row_bcast:31 row_mask:0xc bank_mask:0xf
    s_nop 0
    v_cvt_pk_bf16_f32 v186, v186, v187
    s_mov_b32 s66, 0xbfb8aa3b
    v_lshlrev_b32 v180, 16, v186
    s_add_u32 s71, s100, 8192
    buffer_load_dwordx4 v[64:67], v12, s[40:43], s71 offen sc1
    v_and_b32 v181, s61, v186
    v_mul_f32 v180, s66, v180
    v_mul_f32 v181, s66, v181
    v_exp_f32 v180, v180
    v_exp_f32 v181, v181
    s_nop 0
    v_add_f32 v180, 1.0, v180
    v_add_f32 v181, 1.0, v181
    v_rcp_f32 v180, v180
    v_rcp_f32 v181, v181
    s_nop 0
    v_cvt_pk_bf16_f32 v186, v180, v181
    v_lshlrev_b32 v180, 16, v186
    v_and_b32 v182, s61, v186
    buffer_load_dwordx4 v[68:71], v13, s[40:43], s71 offen sc1
    v_sub_f32 v181, 1.0, v180
    v_sub_f32 v183, 1.0, v182
    v_cvt_pk_bf16_f32 v186, v181, v183
    v_lshlrev_b32 v181, 16, v186
    v_and_b32 v183, s61, v186
    s_mov_b32 exec_lo, 0
    s_mov_b32 exec_hi, 0x80000000
    buffer_store_dwordx4 v[180:183], v9, s[40:43], s67 offen sc1
    s_mov_b64 exec, -1
    v_and_b32 v2, 15, v1
    s_lshl_b32 s56, s70, 6
    s_lshl_b32 s57, s3, 4
    s_add_u32 s56, s56, s57
    v_add_u32 v2, s56, v2
    v_lshrrev_b32 v3, 4, v1
    v_lshlrev_b32 v4, 10, v2
    v_lshl_add_u32 v4, v3, 4, v4
    buffer_load_dwordx4 v[72:75], v14, s[40:43], s71 offen sc1
    s_lshl_b32 s56, s69, 7
    v_add_u32 v16, s56, v4
    v_lshlrev_b32 v5, 15, v3
    v_lshl_add_u32 v17, v2, 2, v5
    v_lshlrev_b32 v11, 3, v2
    v_add_u32 v11, 49152, v11
    s_lshr_b32 s56, s70, 3
    s_lshl_b32 s56, s56, 8
    s_lshl_b32 s57, s69, 5
    s_add_u32 s56, s56, s57
    s_lshl_b32 s56, s56, 7
    s_add_u32 s56, s56, 262144
    s_add_u32 s56, s56, s59
    v_and_b32 v2, 7, v1
    buffer_load_dwordx4 v[76:79], v15, s[40:43], s71 offen sc1
    v_lshl_add_u32 v2, v2, 7, s56
    s_lshl_b32 s57, s70, 2
    s_add_u32 s57, s57, s3
    s_lshl_b32 s57, s57, 8
    s_add_u32 s57, s57, 262144
    v_and_b32 v3, 3, v1
    v_bfe_u32 v4, v1, 2, 1
    v_lshlrev_b32 v3, 15, v3
    v_lshl_add_u32 v3, v4, 7, v3
    v_add_u32 v3, s57, v3
    v_cmp_gt_u32 vcc, 32, v1
    s_lshl_b32 s74, s69, 18
    s_add_u32 s74, s74, 4194304
    v_cndmask_b32 v8, v3, v2, vcc
    s_waitcnt vmcnt(9)
    v_mfma_f32_16x16x32_bf16 v[192:195], a[0:3], v[32:35], 0
    s_add_u32 s71, s100, 12288
    buffer_load_dwordx4 v[80:83], v12, s[40:43], s71 offen sc1
    v_mfma_f32_16x16x32_bf16 v[208:211], a[0:3], v[36:39], 0
    v_mfma_f32_16x16x32_bf16 v[224:227], a[0:3], v[40:43], 0
    v_mfma_f32_16x16x32_bf16 v[240:243], a[0:3], v[44:47], 0
    v_mfma_f32_16x16x32_bf16 v[196:199], a[4:7], v[32:35], 0
    buffer_load_dwordx4 v[84:87], v13, s[40:43], s71 offen sc1
    v_mfma_f32_16x16x32_bf16 v[212:215], a[4:7], v[36:39], 0
    v_mfma_f32_16x16x32_bf16 v[228:231], a[4:7], v[40:43], 0
    v_mfma_f32_16x16x32_bf16 v[244:247], a[4:7], v[44:47], 0
    v_mfma_f32_16x16x32_bf16 v[200:203], a[8:11], v[32:35], 0
    buffer_load_dwordx4 v[88:91], v14, s[40:43], s71 offen sc1
    v_mfma_f32_16x16x32_bf16 v[216:219], a[8:11], v[36:39], 0
    v_mfma_f32_16x16x32_bf16 v[232:235], a[8:11], v[40:43], 0
    v_mfma_f32_16x16x32_bf16 v[248:251], a[8:11], v[44:47], 0
    v_mfma_f32_16x16x32_bf16 v[204:207], a[12:15], v[32:35], 0
    buffer_load_dwordx4 v[92:95], v15, s[40:43], s71 offen sc1
    v_mfma_f32_16x16x32_bf16 v[220:223], a[12:15], v[36:39], 0
    v_mfma_f32_16x16x32_bf16 v[236:239], a[12:15], v[40:43], 0
    v_mfma_f32_16x16x32_bf16 v[252:255], a[12:15], v[44:47], 0
    s_waitcnt vmcnt(9)
    v_mfma_f32_16x16x32_bf16 v[192:195], a[16:19], v[48:51], v[192:195]
    s_add_u32 s71, s100, 16384
    buffer_load_dwordx4 v[32:35], v12, s[40:43], s71 offen sc1
    v_mfma_f32_16x16x32_bf16 v[208:211], a[16:19], v[52:55], v[208:211]
    v_mfma_f32_16x16x32_bf16 v[224:227], a[16:19], v[56:59], v[224:227]
    v_mfma_f32_16x16x32_bf16 v[240:243], a[16:19], v[60:63], v[240:243]
    v_mfma_f32_16x16x32_bf16 v[196:199], a[20:23], v[48:51], v[196:199]
    buffer_load_dwordx4 v[36:39], v13, s[40:43], s71 offen sc1
    v_mfma_f32_16x16x32_bf16 v[212:215], a[20:23], v[52:55], v[212:215]
    v_mfma_f32_16x16x32_bf16 v[228:231], a[20:23], v[56:59], v[228:231]
    v_mfma_f32_16x16x32_bf16 v[244:247], a[20:23], v[60:63], v[244:247]
    v_mfma_f32_16x16x32_bf16 v[200:203], a[24:27], v[48:51], v[200:203]
    buffer_load_dwordx4 v[40:43], v14, s[40:43], s71 offen sc1
    v_mfma_f32_16x16x32_bf16 v[216:219], a[24:27], v[52:55], v[216:219]
    v_mfma_f32_16x16x32_bf16 v[232:235], a[24:27], v[56:59], v[232:235]
    v_mfma_f32_16x16x32_bf16 v[248:251], a[24:27], v[60:63], v[248:251]
    v_mfma_f32_16x16x32_bf16 v[204:207], a[28:31], v[48:51], v[204:207]
    buffer_load_dwordx4 v[44:47], v15, s[40:43], s71 offen sc1
    v_mfma_f32_16x16x32_bf16 v[220:223], a[28:31], v[52:55], v[220:223]
    v_mfma_f32_16x16x32_bf16 v[236:239], a[28:31], v[56:59], v[236:239]
    v_mfma_f32_16x16x32_bf16 v[252:255], a[28:31], v[60:63], v[252:255]
    s_waitcnt vmcnt(8)
    v_mfma_f32_16x16x32_bf16 v[192:195], a[32:35], v[64:67], v[192:195]
    s_add_u32 s71, s100, 20480
    buffer_load_dwordx4 v[48:51], v12, s[40:43], s71 offen sc1
    s_mov_b64 exec, 1
    buffer_store_dwordx2 v[18:19], v9, s[40:43], s75 offen sc1
    s_mov_b64 exec, -1
    v_mfma_f32_16x16x32_bf16 v[208:211], a[32:35], v[68:71], v[208:211]
    v_mfma_f32_16x16x32_bf16 v[224:227], a[32:35], v[72:75], v[224:227]
    v_mfma_f32_16x16x32_bf16 v[240:243], a[32:35], v[76:79], v[240:243]
    v_mfma_f32_16x16x32_bf16 v[196:199], a[36:39], v[64:67], v[196:199]
    buffer_load_dwordx4 v[52:55], v13, s[40:43], s71 offen sc1
    v_mfma_f32_16x16x32_bf16 v[212:215], a[36:39], v[68:71], v[212:215]
    v_mfma_f32_16x16x32_bf16 v[228:231], a[36:39], v[72:75], v[228:231]
    v_mfma_f32_16x16x32_bf16 v[244:247], a[36:39], v[76:79], v[244:247]
    v_mfma_f32_16x16x32_bf16 v[200:203], a[40:43], v[64:67], v[200:203]
    buffer_load_dwordx4 v[56:59], v14, s[40:43], s71 offen sc1
    v_mfma_f32_16x16x32_bf16 v[216:219], a[40:43], v[68:71], v[216:219]
    v_mfma_f32_16x16x32_bf16 v[232:235], a[40:43], v[72:75], v[232:235]
    v_mfma_f32_16x16x32_bf16 v[248:251], a[40:43], v[76:79], v[248:251]
    v_mfma_f32_16x16x32_bf16 v[204:207], a[44:47], v[64:67], v[204:207]
    buffer_load_dwordx4 v[60:63], v15, s[40:43], s71 offen sc1
    v_mfma_f32_16x16x32_bf16 v[220:223], a[44:47], v[68:71], v[220:223]
    v_mfma_f32_16x16x32_bf16 v[236:239], a[44:47], v[72:75], v[236:239]
    v_mfma_f32_16x16x32_bf16 v[252:255], a[44:47], v[76:79], v[252:255]
    s_waitcnt vmcnt(9)
    v_mfma_f32_16x16x32_bf16 v[192:195], a[48:51], v[80:83], v[192:195]
    s_add_u32 s71, s100, 24576
    buffer_load_dwordx4 v[64:67], v12, s[40:43], s71 offen sc1
    v_mfma_f32_16x16x32_bf16 v[208:211], a[48:51], v[84:87], v[208:211]
    v_mfma_f32_16x16x32_bf16 v[224:227], a[48:51], v[88:91], v[224:227]
    v_mfma_f32_16x16x32_bf16 v[240:243], a[48:51], v[92:95], v[240:243]
    v_mfma_f32_16x16x32_bf16 v[196:199], a[52:55], v[80:83], v[196:199]
    buffer_load_dwordx4 v[68:71], v13, s[40:43], s71 offen sc1
    v_mfma_f32_16x16x32_bf16 v[212:215], a[52:55], v[84:87], v[212:215]
    v_mfma_f32_16x16x32_bf16 v[228:231], a[52:55], v[88:91], v[228:231]
    v_mfma_f32_16x16x32_bf16 v[244:247], a[52:55], v[92:95], v[244:247]
    v_mfma_f32_16x16x32_bf16 v[200:203], a[56:59], v[80:83], v[200:203]
    buffer_load_dwordx4 v[72:75], v14, s[40:43], s71 offen sc1
    v_mfma_f32_16x16x32_bf16 v[216:219], a[56:59], v[84:87], v[216:219]
    v_mfma_f32_16x16x32_bf16 v[232:235], a[56:59], v[88:91], v[232:235]
    v_mfma_f32_16x16x32_bf16 v[248:251], a[56:59], v[92:95], v[248:251]
    v_mfma_f32_16x16x32_bf16 v[204:207], a[60:63], v[80:83], v[204:207]
    buffer_load_dwordx4 v[76:79], v15, s[40:43], s71 offen sc1
    v_mfma_f32_16x16x32_bf16 v[220:223], a[60:63], v[84:87], v[220:223]
    v_mfma_f32_16x16x32_bf16 v[236:239], a[60:63], v[88:91], v[236:239]
    v_mfma_f32_16x16x32_bf16 v[252:255], a[60:63], v[92:95], v[252:255]
    s_waitcnt vmcnt(9)
    v_mfma_f32_16x16x32_bf16 v[192:195], a[64:67], v[32:35], v[192:195]
    s_add_u32 s71, s100, 28672
    buffer_load_dwordx4 v[80:83], v12, s[40:43], s71 offen sc1
    v_mfma_f32_16x16x32_bf16 v[208:211], a[64:67], v[36:39], v[208:211]
    v_mfma_f32_16x16x32_bf16 v[224:227], a[64:67], v[40:43], v[224:227]
    v_mfma_f32_16x16x32_bf16 v[240:243], a[64:67], v[44:47], v[240:243]
    v_mfma_f32_16x16x32_bf16 v[196:199], a[68:71], v[32:35], v[196:199]
    buffer_load_dwordx4 v[84:87], v13, s[40:43], s71 offen sc1
    v_mfma_f32_16x16x32_bf16 v[212:215], a[68:71], v[36:39], v[212:215]
    v_mfma_f32_16x16x32_bf16 v[228:231], a[68:71], v[40:43], v[228:231]
    v_mfma_f32_16x16x32_bf16 v[244:247], a[68:71], v[44:47], v[244:247]
    v_mfma_f32_16x16x32_bf16 v[200:203], a[72:75], v[32:35], v[200:203]
    buffer_load_dwordx4 v[88:91], v14, s[40:43], s71 offen sc1
    v_mfma_f32_16x16x32_bf16 v[216:219], a[72:75], v[36:39], v[216:219]
    v_mfma_f32_16x16x32_bf16 v[232:235], a[72:75], v[40:43], v[232:235]
    v_mfma_f32_16x16x32_bf16 v[248:251], a[72:75], v[44:47], v[248:251]
    v_mfma_f32_16x16x32_bf16 v[204:207], a[76:79], v[32:35], v[204:207]
    buffer_load_dwordx4 v[92:95], v15, s[40:43], s71 offen sc1
    v_mfma_f32_16x16x32_bf16 v[220:223], a[76:79], v[36:39], v[220:223]
    v_mfma_f32_16x16x32_bf16 v[236:239], a[76:79], v[40:43], v[236:239]
    v_mfma_f32_16x16x32_bf16 v[252:255], a[76:79], v[44:47], v[252:255]
    s_waitcnt vmcnt(8)
    v_mfma_f32_16x16x32_bf16 v[192:195], a[80:83], v[48:51], v[192:195]
    s_add_u32 s71, s100, 32768
    buffer_load_dwordx4 v[32:35], v12, s[40:43], s71 offen sc1
    v_mfma_f32_16x16x32_bf16 v[208:211], a[80:83], v[52:55], v[208:211]
    v_mfma_f32_16x16x32_bf16 v[224:227], a[80:83], v[56:59], v[224:227]
    v_mfma_f32_16x16x32_bf16 v[240:243], a[80:83], v[60:63], v[240:243]
    v_mfma_f32_16x16x32_bf16 v[196:199], a[84:87], v[48:51], v[196:199]
    buffer_load_dwordx4 v[36:39], v13, s[40:43], s71 offen sc1
    v_mfma_f32_16x16x32_bf16 v[212:215], a[84:87], v[52:55], v[212:215]
    v_mfma_f32_16x16x32_bf16 v[228:231], a[84:87], v[56:59], v[228:231]
    v_mfma_f32_16x16x32_bf16 v[244:247], a[84:87], v[60:63], v[244:247]
    v_mfma_f32_16x16x32_bf16 v[200:203], a[88:91], v[48:51], v[200:203]
    buffer_load_dwordx4 v[40:43], v14, s[40:43], s71 offen sc1
    v_mfma_f32_16x16x32_bf16 v[216:219], a[88:91], v[52:55], v[216:219]
    v_mfma_f32_16x16x32_bf16 v[232:235], a[88:91], v[56:59], v[232:235]
    v_mfma_f32_16x16x32_bf16 v[248:251], a[88:91], v[60:63], v[248:251]
    v_mfma_f32_16x16x32_bf16 v[204:207], a[92:95], v[48:51], v[204:207]
    buffer_load_dwordx4 v[44:47], v15, s[40:43], s71 offen sc1
    v_mfma_f32_16x16x32_bf16 v[220:223], a[92:95], v[52:55], v[220:223]
    v_mfma_f32_16x16x32_bf16 v[236:239], a[92:95], v[56:59], v[236:239]
    v_mfma_f32_16x16x32_bf16 v[252:255], a[92:95], v[60:63], v[252:255]
    s_waitcnt vmcnt(8)
    v_mfma_f32_16x16x32_bf16 v[192:195], a[96:99], v[64:67], v[192:195]
    s_add_u32 s71, s100, 36864
    buffer_load_dwordx4 v[48:51], v12, s[40:43], s71 offen sc1
    v_mfma_f32_16x16x32_bf16 v[208:211], a[96:99], v[68:71], v[208:211]
    v_mfma_f32_16x16x32_bf16 v[224:227], a[96:99], v[72:75], v[224:227]
    v_mfma_f32_16x16x32_bf16 v[240:243], a[96:99], v[76:79], v[240:243]
    v_mfma_f32_16x16x32_bf16 v[196:199], a[100:103], v[64:67], v[196:199]
    buffer_load_dwordx4 v[52:55], v13, s[40:43], s71 offen sc1
    v_mfma_f32_16x16x32_bf16 v[212:215], a[100:103], v[68:71], v[212:215]
    v_mfma_f32_16x16x32_bf16 v[228:231], a[100:103], v[72:75], v[228:231]
    v_mfma_f32_16x16x32_bf16 v[244:247], a[100:103], v[76:79], v[244:247]
    v_mfma_f32_16x16x32_bf16 v[200:203], a[104:107], v[64:67], v[200:203]
    buffer_load_dwordx4 v[56:59], v14, s[40:43], s71 offen sc1
    v_mfma_f32_16x16x32_bf16 v[216:219], a[104:107], v[68:71], v[216:219]
    v_mfma_f32_16x16x32_bf16 v[232:235], a[104:107], v[72:75], v[232:235]
    v_mfma_f32_16x16x32_bf16 v[248:251], a[104:107], v[76:79], v[248:251]
    v_mfma_f32_16x16x32_bf16 v[204:207], a[108:111], v[64:67], v[204:207]
    buffer_load_dwordx4 v[60:63], v15, s[40:43], s71 offen sc1
    v_mfma_f32_16x16x32_bf16 v[220:223], a[108:111], v[68:71], v[220:223]
    v_mfma_f32_16x16x32_bf16 v[236:239], a[108:111], v[72:75], v[236:239]
    v_mfma_f32_16x16x32_bf16 v[252:255], a[108:111], v[76:79], v[252:255]
    s_waitcnt vmcnt(8)
    v_mfma_f32_16x16x32_bf16 v[192:195], a[112:115], v[80:83], v[192:195]
    s_add_u32 s71, s100, 40960
    buffer_load_dwordx4 v[64:67], v12, s[40:43], s71 offen sc1
    v_mfma_f32_16x16x32_bf16 v[208:211], a[112:115], v[84:87], v[208:211]
    v_mfma_f32_16x16x32_bf16 v[224:227], a[112:115], v[88:91], v[224:227]
    v_mfma_f32_16x16x32_bf16 v[240:243], a[112:115], v[92:95], v[240:243]
    v_mfma_f32_16x16x32_bf16 v[196:199], a[116:119], v[80:83], v[196:199]
    buffer_load_dwordx4 v[68:71], v13, s[40:43], s71 offen sc1
    v_mfma_f32_16x16x32_bf16 v[212:215], a[116:119], v[84:87], v[212:215]
    v_mfma_f32_16x16x32_bf16 v[228:231], a[116:119], v[88:91], v[228:231]
    v_mfma_f32_16x16x32_bf16 v[244:247], a[116:119], v[92:95], v[244:247]
    v_mfma_f32_16x16x32_bf16 v[200:203], a[120:123], v[80:83], v[200:203]
    buffer_load_dwordx4 v[72:75], v14, s[40:43], s71 offen sc1
    v_mfma_f32_16x16x32_bf16 v[216:219], a[120:123], v[84:87], v[216:219]
    v_mfma_f32_16x16x32_bf16 v[232:235], a[120:123], v[88:91], v[232:235]
    v_mfma_f32_16x16x32_bf16 v[248:251], a[120:123], v[92:95], v[248:251]
    v_mfma_f32_16x16x32_bf16 v[204:207], a[124:127], v[80:83], v[204:207]
    buffer_load_dwordx4 v[76:79], v15, s[40:43], s71 offen sc1
    v_mfma_f32_16x16x32_bf16 v[220:223], a[124:127], v[84:87], v[220:223]
    v_mfma_f32_16x16x32_bf16 v[236:239], a[124:127], v[88:91], v[236:239]
    v_mfma_f32_16x16x32_bf16 v[252:255], a[124:127], v[92:95], v[252:255]
    s_waitcnt vmcnt(8)
    v_mfma_f32_16x16x32_bf16 v[192:195], a[128:131], v[32:35], v[192:195]
    s_add_u32 s71, s100, 45056
    buffer_load_dwordx4 v[80:83], v12, s[40:43], s71 offen sc1
    buffer_load_dwordx2 v[6:7], v8, s[40:43], 0 offen sc1
    v_mfma_f32_16x16x32_bf16 v[208:211], a[128:131], v[36:39], v[208:211]
    v_mfma_f32_16x16x32_bf16 v[224:227], a[128:131], v[40:43], v[224:227]
    v_mfma_f32_16x16x32_bf16 v[240:243], a[128:131], v[44:47], v[240:243]
    v_mfma_f32_16x16x32_bf16 v[196:199], a[132:135], v[32:35], v[196:199]
    buffer_load_dwordx4 v[84:87], v13, s[40:43], s71 offen sc1
    v_mfma_f32_16x16x32_bf16 v[212:215], a[132:135], v[36:39], v[212:215]
    v_mfma_f32_16x16x32_bf16 v[228:231], a[132:135], v[40:43], v[228:231]
    v_mfma_f32_16x16x32_bf16 v[244:247], a[132:135], v[44:47], v[244:247]
    v_mfma_f32_16x16x32_bf16 v[200:203], a[136:139], v[32:35], v[200:203]
    buffer_load_dwordx4 v[88:91], v14, s[40:43], s71 offen sc1
    v_mfma_f32_16x16x32_bf16 v[216:219], a[136:139], v[36:39], v[216:219]
    v_mfma_f32_16x16x32_bf16 v[232:235], a[136:139], v[40:43], v[232:235]
    v_mfma_f32_16x16x32_bf16 v[248:251], a[136:139], v[44:47], v[248:251]
    v_mfma_f32_16x16x32_bf16 v[204:207], a[140:143], v[32:35], v[204:207]
    buffer_load_dwordx4 v[92:95], v15, s[40:43], s71 offen sc1
    v_mfma_f32_16x16x32_bf16 v[220:223], a[140:143], v[36:39], v[220:223]
    v_mfma_f32_16x16x32_bf16 v[236:239], a[140:143], v[40:43], v[236:239]
    v_mfma_f32_16x16x32_bf16 v[252:255], a[140:143], v[44:47], v[252:255]
    s_waitcnt vmcnt(9)
    v_mfma_f32_16x16x32_bf16 v[192:195], a[144:147], v[48:51], v[192:195]
    s_add_u32 s71, s100, 49152
    buffer_load_dwordx4 v[32:35], v12, s[40:43], s71 offen sc1
    v_mfma_f32_16x16x32_bf16 v[208:211], a[144:147], v[52:55], v[208:211]
    v_mfma_f32_16x16x32_bf16 v[224:227], a[144:147], v[56:59], v[224:227]
    v_mfma_f32_16x16x32_bf16 v[240:243], a[144:147], v[60:63], v[240:243]
    v_mfma_f32_16x16x32_bf16 v[196:199], a[148:151], v[48:51], v[196:199]
    buffer_load_dwordx4 v[36:39], v13, s[40:43], s71 offen sc1
    v_mfma_f32_16x16x32_bf16 v[212:215], a[148:151], v[52:55], v[212:215]
    v_mfma_f32_16x16x32_bf16 v[228:231], a[148:151], v[56:59], v[228:231]
    v_mfma_f32_16x16x32_bf16 v[244:247], a[148:151], v[60:63], v[244:247]
    v_mfma_f32_16x16x32_bf16 v[200:203], a[152:155], v[48:51], v[200:203]
    buffer_load_dwordx4 v[40:43], v14, s[40:43], s71 offen sc1
    v_mfma_f32_16x16x32_bf16 v[216:219], a[152:155], v[52:55], v[216:219]
    v_mfma_f32_16x16x32_bf16 v[232:235], a[152:155], v[56:59], v[232:235]
    v_mfma_f32_16x16x32_bf16 v[248:251], a[152:155], v[60:63], v[248:251]
    v_mfma_f32_16x16x32_bf16 v[204:207], a[156:159], v[48:51], v[204:207]
    buffer_load_dwordx4 v[44:47], v15, s[40:43], s71 offen sc1
    v_mfma_f32_16x16x32_bf16 v[220:223], a[156:159], v[52:55], v[220:223]
    v_mfma_f32_16x16x32_bf16 v[236:239], a[156:159], v[56:59], v[236:239]
    v_mfma_f32_16x16x32_bf16 v[252:255], a[156:159], v[60:63], v[252:255]
    s_waitcnt vmcnt(9)
    v_mfma_f32_16x16x32_bf16 v[192:195], a[160:163], v[64:67], v[192:195]
    s_add_u32 s71, s100, 53248
    buffer_load_dwordx4 v[48:51], v12, s[40:43], s71 offen sc1
    v_mfma_f32_16x16x32_bf16 v[208:211], a[160:163], v[68:71], v[208:211]
    v_mfma_f32_16x16x32_bf16 v[224:227], a[160:163], v[72:75], v[224:227]
    v_mfma_f32_16x16x32_bf16 v[240:243], a[160:163], v[76:79], v[240:243]
    v_mfma_f32_16x16x32_bf16 v[196:199], a[164:167], v[64:67], v[196:199]
    buffer_load_dwordx4 v[52:55], v13, s[40:43], s71 offen sc1
    v_mfma_f32_16x16x32_bf16 v[212:215], a[164:167], v[68:71], v[212:215]
    v_mfma_f32_16x16x32_bf16 v[228:231], a[164:167], v[72:75], v[228:231]
    v_mfma_f32_16x16x32_bf16 v[244:247], a[164:167], v[76:79], v[244:247]
    v_mfma_f32_16x16x32_bf16 v[200:203], a[168:171], v[64:67], v[200:203]
    buffer_load_dwordx4 v[56:59], v14, s[40:43], s71 offen sc1
    v_mfma_f32_16x16x32_bf16 v[216:219], a[168:171], v[68:71], v[216:219]
    v_mfma_f32_16x16x32_bf16 v[232:235], a[168:171], v[72:75], v[232:235]
    v_mfma_f32_16x16x32_bf16 v[248:251], a[168:171], v[76:79], v[248:251]
    v_mfma_f32_16x16x32_bf16 v[204:207], a[172:175], v[64:67], v[204:207]
    buffer_load_dwordx4 v[60:63], v15, s[40:43], s71 offen sc1
    v_mfma_f32_16x16x32_bf16 v[220:223], a[172:175], v[68:71], v[220:223]
    v_mfma_f32_16x16x32_bf16 v[236:239], a[172:175], v[72:75], v[236:239]
    v_mfma_f32_16x16x32_bf16 v[252:255], a[172:175], v[76:79], v[252:255]
    s_waitcnt vmcnt(8)
    v_mfma_f32_16x16x32_bf16 v[192:195], a[176:179], v[80:83], v[192:195]
    v_mfma_f32_16x16x32_bf16 v[208:211], a[176:179], v[84:87], v[208:211]
    v_mfma_f32_16x16x32_bf16 v[224:227], a[176:179], v[88:91], v[224:227]
    v_cmp_ne_u64 vcc, s[54:55], v[6:7]
    s_mov_b32 s56, 0
    s_cmp_eq_u64 vcc, 0
    s_cbranch_scc1 L_ok_pl_4
L_re_pl_4:
    s_sleep 4
    buffer_load_dwordx2 v[6:7], v8, s[40:43], 0 offen sc1
    s_waitcnt vmcnt(0)
    v_cmp_ne_u64 vcc, s[54:55], v[6:7]
    s_add_u32 s56, s56, 1
    s_cmp_eq_u64 vcc, 0
    s_cbranch_scc1 L_ok_pl_4
    s_cmp_lt_u32 s56, 200000
    s_cbranch_scc1 L_re_pl_4
L_ok_pl_4:
    s_barrier
    v_mfma_f32_16x16x32_bf16 v[240:243], a[176:179], v[92:95], v[240:243]
    buffer_load_dwordx2 v[28:29], v11, s[40:43], 0 offen sc1
    v_mfma_f32_16x16x32_bf16 v[196:199], a[180:183], v[80:83], v[196:199]
    s_add_u32 s57, s74, 0
    buffer_load_dword v160, v17, s[40:43], s57 offen sc1
    v_mfma_f32_16x16x32_bf16 v[212:215], a[180:183], v[84:87], v[212:215]
    s_add_u32 s57, s74, 8192
    buffer_load_dword v161, v17, s[40:43], s57 offen sc1
    v_mfma_f32_16x16x32_bf16 v[228:231], a[180:183], v[88:91], v[228:231]
    v_mfma_f32_16x16x32_bf16 v[244:247], a[180:183], v[92:95], v[244:247]
    s_add_u32 s57, s74, 16384
    buffer_load_dword v162, v17, s[40:43], s57 offen sc1
    v_mfma_f32_16x16x32_bf16 v[200:203], a[184:187], v[80:83], v[200:203]
    s_add_u32 s57, s74, 24576
    buffer_load_dword v163, v17, s[40:43], s57 offen sc1
    v_mfma_f32_16x16x32_bf16 v[216:219], a[184:187], v[84:87], v[216:219]
    v_mfma_f32_16x16x32_bf16 v[232:235], a[184:187], v[88:91], v[232:235]
    s_add_u32 s57, s74, 131072
    buffer_load_dword v164, v17, s[40:43], s57 offen sc1
    v_mfma_f32_16x16x32_bf16 v[248:251], a[184:187], v[92:95], v[248:251]
    s_add_u32 s57, s74, 139264
    buffer_load_dword v165, v17, s[40:43], s57 offen sc1
    v_mfma_f32_16x16x32_bf16 v[204:207], a[188:191], v[80:83], v[204:207]
    v_mfma_f32_16x16x32_bf16 v[220:223], a[188:191], v[84:87], v[220:223]
    s_add_u32 s57, s74, 147456
    buffer_load_dword v166, v17, s[40:43], s57 offen sc1
    v_mfma_f32_16x16x32_bf16 v[236:239], a[188:191], v[88:91], v[236:239]
    s_add_u32 s57, s74, 155648
    buffer_load_dword v167, v17, s[40:43], s57 offen sc1
    v_mfma_f32_16x16x32_bf16 v[252:255], a[188:191], v[92:95], v[252:255]
    s_waitcnt vmcnt(13)
    v_mfma_f32_16x16x32_bf16 v[192:195], a[192:195], v[32:35], v[192:195]
    s_add_u32 s56, s3, 1
    s_and_b32 s56, s56, 3
    s_mul_i32 s56, s56, 12288
    s_add_u32 s56, s56, 45056
    v_add_u32 v13, s56, v10
    v_mfma_f32_16x16x32_bf16 v[208:211], a[192:195], v[36:39], v[208:211]
    v_mfma_f32_16x16x32_bf16 v[224:227], a[192:195], v[40:43], v[224:227]
    buffer_load_dwordx4 v[20:23], v16, s[8:11], 0 offen
    v_mfma_f32_16x16x32_bf16 v[240:243], a[192:195], v[44:47], v[240:243]
    v_mfma_f32_16x16x32_bf16 v[196:199], a[196:199], v[32:35], v[196:199]
    s_add_u32 s56, s3, 2
    s_and_b32 s56, s56, 3
    s_mul_i32 s56, s56, 12288
    s_add_u32 s56, s56, 49152
    v_add_u32 v14, s56, v10
    v_mfma_f32_16x16x32_bf16 v[212:215], a[196:199], v[36:39], v[212:215]
    v_mfma_f32_16x16x32_bf16 v[228:231], a[196:199], v[40:43], v[228:231]
    v_mfma_f32_16x16x32_bf16 v[244:247], a[196:199], v[44:47], v[244:247]
    v_mfma_f32_16x16x32_bf16 v[200:203], a[200:203], v[32:35], v[200:203]
    s_add_u32 s56, s3, 3
    s_and_b32 s56, s56, 3
    s_mul_i32 s56, s56, 12288
    s_add_u32 s56, s56, 53248
    v_add_u32 v15, s56, v10
    v_mfma_f32_16x16x32_bf16 v[216:219], a[200:203], v[36:39], v[216:219]
    v_mfma_f32_16x16x32_bf16 v[232:235], a[200:203], v[40:43], v[232:235]
    buffer_load_dwordx4 v[24:27], v16, s[8:11], 0 offen offset:64
    v_mfma_f32_16x16x32_bf16 v[248:251], a[200:203], v[44:47], v[248:251]
    v_mfma_f32_16x16x32_bf16 v[204:207], a[204:207], v[32:35], v[204:207]
    s_mul_i32 s56, s3, 12288
    s_add_u32 s56, s56, 45056
    v_add_u32 v12, s56, v10
    v_mfma_f32_16x16x32_bf16 v[220:223], a[204:207], v[36:39], v[220:223]
    v_mfma_f32_16x16x32_bf16 v[236:239], a[204:207], v[40:43], v[236:239]
    v_mfma_f32_16x16x32_bf16 v[252:255], a[204:207], v[44:47], v[252:255]
    s_waitcnt vmcnt(11)
    v_mfma_f32_16x16x32_bf16 v[208:211], a[208:211], v[52:55], v[208:211]
    v_mfma_f32_16x16x32_bf16 v[212:215], a[212:215], v[52:55], v[212:215]
    v_mfma_f32_16x16x32_bf16 v[216:219], a[216:219], v[52:55], v[216:219]
    v_mfma_f32_16x16x32_bf16 v[220:223], a[220:223], v[52:55], v[220:223]
    v_mfma_f32_16x16x32_bf16 v[224:227], a[208:211], v[56:59], v[224:227]
    v_mfma_f32_16x16x32_bf16 v[228:231], a[212:215], v[56:59], v[228:231]
    v_mfma_f32_16x16x32_bf16 v[232:235], a[216:219], v[56:59], v[232:235]
    v_mfma_f32_16x16x32_bf16 v[236:239], a[220:223], v[56:59], v[236:239]
    v_mfma_f32_16x16x32_bf16 v[240:243], a[208:211], v[60:63], v[240:243]
    v_mfma_f32_16x16x32_bf16 v[244:247], a[212:215], v[60:63], v[244:247]
    ds_write_b128 v13, v[208:211] offset:0
    v_mfma_f32_16x16x32_bf16 v[248:251], a[216:219], v[60:63], v[248:251]
    ds_write_b128 v13, v[212:215] offset:1024
    v_mfma_f32_16x16x32_bf16 v[252:255], a[220:223], v[60:63], v[252:255]
    ds_write_b128 v13, v[216:219] offset:2048
    v_mfma_f32_16x16x32_bf16 v[192:195], a[208:211], v[48:51], v[192:195]
    ds_write_b128 v13, v[220:223] offset:3072
    v_mfma_f32_16x16x32_bf16 v[196:199], a[212:215], v[48:51], v[196:199]
    ds_write_b128 v14, v[224:227] offset:0
    v_mfma_f32_16x16x32_bf16 v[200:203], a[216:219], v[48:51], v[200:203]
    ds_write_b128 v14, v[228:231] offset:1024
    v_mfma_f32_16x16x32_bf16 v[204:207], a[220:223], v[48:51], v[204:207]
    ds_write_b128 v14, v[232:235] offset:2048
    ds_write_b128 v14, v[236:239] offset:3072
    ds_write_b128 v15, v[240:243] offset:0
    ds_write_b128 v15, v[244:247] offset:1024
    ds_write_b128 v15, v[248:251] offset:2048
    ds_write_b128 v15, v[252:255] offset:3072
    s_waitcnt vmcnt(2)
    s_waitcnt vmcnt(0)
    v_lshlrev_b32 v128, 16, v20
    v_and_b32 v129, s61, v20
    v_lshlrev_b32 v52, 16, v160
    v_and_b32 v53, s61, v160
    v_pk_mul_f32 v[128:129], v[128:129], v[52:53]
    v_pk_mul_f32 v[128:129], v[128:129], v[28:29] op_sel_hi:[1,0]

    v_lshlrev_b32 v130, 16, v21
    v_and_b32 v131, s61, v21
    v_lshlrev_b32 v52, 16, v161
    v_and_b32 v53, s61, v161
    v_pk_mul_f32 v[130:131], v[130:131], v[52:53]
    v_pk_mul_f32 v[130:131], v[130:131], v[28:29] op_sel_hi:[1,0]

    v_lshlrev_b32 v132, 16, v22
    v_and_b32 v133, s61, v22
    v_lshlrev_b32 v52, 16, v162
    v_and_b32 v53, s61, v162
    v_pk_mul_f32 v[132:133], v[132:133], v[52:53]
    v_pk_mul_f32 v[132:133], v[132:133], v[28:29] op_sel_hi:[1,0]

    v_lshlrev_b32 v134, 16, v23
    v_and_b32 v135, s61, v23
    v_lshlrev_b32 v52, 16, v163
    v_and_b32 v53, s61, v163
    v_pk_mul_f32 v[134:135], v[134:135], v[52:53]
    v_pk_mul_f32 v[134:135], v[134:135], v[28:29] op_sel_hi:[1,0]

    s_waitcnt lgkmcnt(0)
    s_barrier
    ds_read_b128 v[64:67], v12 offset:0
    ds_read_b128 v[80:83], v12 offset:4096
    ds_read_b128 v[96:99], v12 offset:8192
    ds_read_b128 v[68:71], v12 offset:1024
    ds_read_b128 v[84:87], v12 offset:5120
    ds_read_b128 v[100:103], v12 offset:9216
    ds_read_b128 v[72:75], v12 offset:2048
    ds_read_b128 v[88:91], v12 offset:6144
    ds_read_b128 v[104:107], v12 offset:10240
    ds_read_b128 v[76:79], v12 offset:3072
    ds_read_b128 v[92:95], v12 offset:7168
    ds_read_b128 v[108:111], v12 offset:11264
    v_lshlrev_b32 v136, 16, v24
    v_and_b32 v137, s61, v24
    v_lshlrev_b32 v52, 16, v164
    v_and_b32 v53, s61, v164
    v_pk_mul_f32 v[136:137], v[136:137], v[52:53]
    v_pk_mul_f32 v[136:137], v[136:137], v[28:29] op_sel_hi:[1,0]

    v_lshlrev_b32 v138, 16, v25
    v_and_b32 v139, s61, v25
    v_lshlrev_b32 v52, 16, v165
    v_and_b32 v53, s61, v165
    v_pk_mul_f32 v[138:139], v[138:139], v[52:53]
    v_pk_mul_f32 v[138:139], v[138:139], v[28:29] op_sel_hi:[1,0]

    v_lshlrev_b32 v140, 16, v26
    v_and_b32 v141, s61, v26
    v_lshlrev_b32 v52, 16, v166
    v_and_b32 v53, s61, v166
    v_pk_mul_f32 v[140:141], v[140:141], v[52:53]
    v_pk_mul_f32 v[140:141], v[140:141], v[28:29] op_sel_hi:[1,0]

    v_lshlrev_b32 v142, 16, v27
    v_and_b32 v143, s61, v27
    v_lshlrev_b32 v52, 16, v167
    v_and_b32 v53, s61, v167
    v_pk_mul_f32 v[142:143], v[142:143], v[52:53]
    v_pk_mul_f32 v[142:143], v[142:143], v[28:29] op_sel_hi:[1,0]

    s_waitcnt lgkmcnt(6)
    v_pk_add_f32 v[192:193], v[192:193], v[64:65]
    v_pk_add_f32 v[194:195], v[194:195], v[66:67]
    v_pk_add_f32 v[196:197], v[196:197], v[68:69]
    v_pk_add_f32 v[198:199], v[198:199], v[70:71]
    v_pk_add_f32 v[192:193], v[192:193], v[80:81]
    v_pk_add_f32 v[194:195], v[194:195], v[82:83]
    v_pk_add_f32 v[196:197], v[196:197], v[84:85]
    v_pk_add_f32 v[198:199], v[198:199], v[86:87]
    v_pk_add_f32 v[192:193], v[192:193], v[96:97]
    v_pk_add_f32 v[194:195], v[194:195], v[98:99]
    v_pk_add_f32 v[196:197], v[196:197], v[100:101]
    v_pk_add_f32 v[198:199], v[198:199], v[102:103]
    v_pk_fma_f32 v[128:129], v[192:193], v[28:29], v[128:129] op_sel:[0,1,0] op_sel_hi:[1,1,1]
    v_pk_fma_f32 v[130:131], v[194:195], v[28:29], v[130:131] op_sel:[0,1,0] op_sel_hi:[1,1,1]
    v_pk_fma_f32 v[132:133], v[196:197], v[28:29], v[132:133] op_sel:[0,1,0] op_sel_hi:[1,1,1]
    v_pk_fma_f32 v[134:135], v[198:199], v[28:29], v[134:135] op_sel:[0,1,0] op_sel_hi:[1,1,1]
    v_cvt_pk_bf16_f32 v56, v128, v129
    v_cvt_pk_bf16_f32 v57, v130, v131
    v_cvt_pk_bf16_f32 v58, v132, v133
    v_cvt_pk_bf16_f32 v59, v134, v135
    buffer_store_dwordx4 v[56:59], v16, s[36:39], 0 offen offset:0
    s_waitcnt lgkmcnt(0)
    v_pk_add_f32 v[200:201], v[200:201], v[72:73]
    v_pk_add_f32 v[202:203], v[202:203], v[74:75]
    v_pk_add_f32 v[204:205], v[204:205], v[76:77]
    v_pk_add_f32 v[206:207], v[206:207], v[78:79]
    v_pk_add_f32 v[200:201], v[200:201], v[88:89]
    v_pk_add_f32 v[202:203], v[202:203], v[90:91]
    v_pk_add_f32 v[204:205], v[204:205], v[92:93]
    v_pk_add_f32 v[206:207], v[206:207], v[94:95]
    v_pk_add_f32 v[200:201], v[200:201], v[104:105]
    v_pk_add_f32 v[202:203], v[202:203], v[106:107]
    v_pk_add_f32 v[204:205], v[204:205], v[108:109]
    v_pk_add_f32 v[206:207], v[206:207], v[110:111]
    v_pk_fma_f32 v[136:137], v[200:201], v[28:29], v[136:137] op_sel:[0,1,0] op_sel_hi:[1,1,1]
    v_pk_fma_f32 v[138:139], v[202:203], v[28:29], v[138:139] op_sel:[0,1,0] op_sel_hi:[1,1,1]
    v_pk_fma_f32 v[140:141], v[204:205], v[28:29], v[140:141] op_sel:[0,1,0] op_sel_hi:[1,1,1]
    v_pk_fma_f32 v[142:143], v[206:207], v[28:29], v[142:143] op_sel:[0,1,0] op_sel_hi:[1,1,1]
    v_cvt_pk_bf16_f32 v60, v136, v137
    v_cvt_pk_bf16_f32 v61, v138, v139
    v_cvt_pk_bf16_f32 v62, v140, v141
    v_cvt_pk_bf16_f32 v63, v142, v143
    buffer_store_dwordx4 v[60:63], v16, s[36:39], 0 offen offset:64
L_end:
    s_endpgm
L_spare:
    s_sub_u32 s6, s5, 28
    s_lshl_b32 s7, s4, 2
    s_add_u32 s7, s7, s6

    s_getpc_b64 s[96:97]
L_pc:
    s_sub_u32 s96, s96, L_pc-gated_mix__ssm_conv_h3__glu_gated_bilinear__prompt_kernel
    s_subb_u32 s97, s97, 0
    v_lshlrev_b32 v2, 7, v0
    v_min_u32 v2, L_code_end-gated_mix__ssm_conv_h3__glu_gated_bilinear__prompt_kernel-4, v2
    global_load_dword v39, v2, s[96:97]

    s_lshl_b32 s56, s7, 2
    s_add_u32 s56, s56, s3
    s_cmp_lt_u32 s56, 64
    s_cselect_b32 s96, s24, s28
    s_cselect_b32 s97, s25, s29
    s_and_b32 s57, s56, 63
    s_add_u32 s57, s57, 64
    s_mul_i32 s57, s57, 3584
    s_add_u32 s96, s96, s57
    s_addc_u32 s97, s97, 0
    s_lshl_b32 s57, s56, 14
    s_add_u32 s57, s57, 128
    s_add_u32 s98, s8, s57
    s_addc_u32 s99, s9, 0
    v_cmp_gt_u32 vcc, 32, v1
    v_min_u32 v2, 27, v1
    v_lshlrev_b32 v2, 7, v2
    v_and_b32 v3, 15, v1
    v_lshlrev_b32 v3, 10, v3
    v_cndmask_b32 v2, v3, v2, vcc
    v_mov_b32 v3, 0
    v_mov_b32 v4, s96
    v_mov_b32 v5, s98
    v_cndmask_b32 v12, v5, v4, vcc
    v_mov_b32 v4, s97
    v_mov_b32 v5, s99
    v_cndmask_b32 v13, v5, v4, vcc
    v_lshl_add_u64 v[12:13], v[12:13], 0, v[2:3]
    v_mov_b32 v4, 229376
    v_mov_b32 v5, 128
    v_cndmask_b32 v14, v5, v4, vcc
    v_mov_b32 v15, 0

    global_load_dword v41, v[12:13], off
    v_lshl_add_u64 v[12:13], v[12:13], 0, v[14:15]
    s_lshl_b32 s56, s3, 7
    s_add_u32 m0, s56, 117760
    s_mov_b64 exec, 0xff
    buffer_load_dwordx4 v8, s[12:15], 0 offen nt lds
    s_mov_b64 exec, -1
    s_add_u32 m0, s59, 109568
    s_nop 0
    buffer_load_dwordx4 v30, s[12:15], 0 offen nt lds
    s_add_u32 m0, s59, 113664
    s_nop 0
    buffer_load_dwordx4 v31, s[12:15], 0 offen nt lds
    s_add_u32 m0, s59, 101376
    s_nop 0
    buffer_load_dwordx4 v28, s[16:19], 0 offen nt lds
    s_add_u32 m0, s59, 105472
    s_nop 0
    buffer_load_dwordx4 v29, s[16:19], 0 offen nt lds
    global_load_dwordx2 v[30:31], v6, s[48:49]
    global_load_dword v42, v[12:13], off
    v_lshl_add_u64 v[12:13], v[12:13], 0, v[14:15]
    global_load_dword v43, v[12:13], off
    v_lshl_add_u64 v[12:13], v[12:13], 0, v[14:15]
    v_lshrrev_b32 v3, 4, v1
    v_bfe_u32 v4, v1, 2, 2
    v_lshl_add_u32 v3, v3, 4, v4
    v_lshlrev_b32 v3, 7, v3
    v_and_b32 v5, 3, v1
    v_lshl_add_u32 v3, v5, 3, v3
    s_lshl_b32 s56, s3, 5
    s_add_u32 s56, s56, 101376
    v_add_u32 v7, s56, v3
    v_and_b32 v2, 15, v1
    v_mul_u32_u24 v2, 144, v2
    v_lshrrev_b32 v3, 4, v1
    v_sub_u32 v3, 3, v3
    v_lshl_add_u32 v2, v3, 5, v2
    s_add_u32 s56, s62, 135168
    v_add_u32 v2, s56, v2
    v_lshrrev_b32 v3, 3, v1
    v_mul_u32_u24 v4, 144, v3
    v_and_b32 v5, 7, v1
    v_lshl_add_u32 v4, v5, 4, v4
    v_add_u32 v4, s56, v4
    v_lshlrev_b32 v3, 12, v3
    v_lshl_add_u32 v3, v5, 4, v3
    s_lshl_b32 s56, s4, 18
    s_lshl_b32 s57, s3, 16
    s_add_u32 s56, s56, s57
    s_sub_u32 s57, 31, s5
    s_lshl_b32 s57, s57, 7
    s_add_u32 s56, s56, s57
    s_add_u32 s98, s56, 1048576
    s_add_u32 s99, s98, 0x8000
    s_lshl_b32 s74, s58, 7
    s_cmp_eq_u32 s3, 0
    s_cselect_b32 s74, s74, 268435456
    v_lshrrev_b32 v18, 2, v1
    v_lshlrev_b32 v18, 7, v18
    v_and_b32 v5, 3, v1
    v_lshl_add_u32 v18, v5, 4, v18
    s_lshl_b32 s56, s65, 12
    s_lshl_b32 s57, s64, 6
    s_add_u32 s56, s56, s57
    s_add_u32 s56, s56, 118272
    v_add_u32 v5, s56, v18
    s_mul_i32 s75, s4, 56
    s_lshl_b32 s57, s5, 1
    s_add_u32 s75, s75, s57
    s_add_u32 s75, s75, s65
    s_lshl_b32 s75, s75, 12
    s_lshl_b32 s57, s64, 11
    s_add_u32 s75, s75, s57
    s_add_u32 s75, s75, 8388608

    s_waitcnt vmcnt(2)
    s_barrier
    ds_read_b64_tr_b16 v[52:53], v7 offset:8192
    ds_read_b64_tr_b16 v[54:55], v7 offset:8704
    ds_read_b64_tr_b16 v[56:57], v7 offset:9216
    ds_read_b64_tr_b16 v[58:59], v7 offset:9728
    ds_read_b64_tr_b16 v[60:61], v7 offset:10240
    ds_read_b64_tr_b16 v[62:63], v7 offset:0
    ds_read_b64_tr_b16 v[64:65], v7 offset:512
    ds_read_b64_tr_b16 v[66:67], v7 offset:1024
    ds_read_b64_tr_b16 v[68:69], v7 offset:1536
    v_alignbit_b32 v80, v31, v31, 16
    v_alignbit_b32 v81, v30, v30, 16
    v_and_b32 v82, s61, v31
    v_bfi_b32 v83, s61, v30, v31
    v_and_b32 v84, 0xffff, v30
    s_waitcnt lgkmcnt(0)
    v_dot2_f32_bf16 v96, v52, v82, 0
    v_dot2_f32_bf16 v97, v53, v80, 0
    v_dot2_f32_bf16 v98, v53, v82, 0
    v_dot2_f32_bf16 v99, v54, v80, 0
    v_dot2_f32_bf16 v100, v54, v82, 0
    v_dot2_f32_bf16 v101, v55, v80, 0
    v_dot2_f32_bf16 v102, v55, v82, 0
    v_dot2_f32_bf16 v103, v56, v80, 0
    v_dot2_f32_bf16 v104, v56, v82, 0
    v_dot2_f32_bf16 v105, v57, v80, 0
    v_dot2_f32_bf16 v106, v57, v82, 0
    v_dot2_f32_bf16 v107, v58, v80, 0
    v_dot2_f32_bf16 v108, v58, v82, 0
    v_dot2_f32_bf16 v109, v59, v80, 0
    v_dot2_f32_bf16 v110, v59, v82, 0
    v_dot2_f32_bf16 v111, v60, v80, 0
    v_dot2_f32_bf16 v96, v53, v83, v96
    v_dot2_f32_bf16 v97, v54, v81, v97
    v_dot2_f32_bf16 v98, v54, v83, v98
    v_dot2_f32_bf16 v99, v55, v81, v99
    v_dot2_f32_bf16 v100, v55, v83, v100
    v_dot2_f32_bf16 v101, v56, v81, v101
    v_dot2_f32_bf16 v102, v56, v83, v102
    v_dot2_f32_bf16 v103, v57, v81, v103
    v_dot2_f32_bf16 v104, v57, v83, v104
    v_dot2_f32_bf16 v105, v58, v81, v105
    v_dot2_f32_bf16 v106, v58, v83, v106
    v_dot2_f32_bf16 v107, v59, v81, v107
    v_dot2_f32_bf16 v108, v59, v83, v108
    v_dot2_f32_bf16 v109, v60, v81, v109
    v_dot2_f32_bf16 v110, v60, v83, v110
    v_dot2_f32_bf16 v111, v61, v81, v111
    v_dot2_f32_bf16 v96, v54, v84, v96
    v_dot2_f32_bf16 v98, v55, v84, v98
    v_dot2_f32_bf16 v100, v56, v84, v100
    v_dot2_f32_bf16 v102, v57, v84, v102
    v_dot2_f32_bf16 v104, v58, v84, v104
    v_dot2_f32_bf16 v106, v59, v84, v106
    v_dot2_f32_bf16 v108, v60, v84, v108
    v_dot2_f32_bf16 v110, v61, v84, v110
    v_lshlrev_b32 v112, 16, v62
    v_and_b32 v113, s61, v62
    v_lshlrev_b32 v114, 16, v63
    v_and_b32 v115, s61, v63
    v_lshlrev_b32 v116, 16, v64
    v_and_b32 v117, s61, v64
    v_lshlrev_b32 v118, 16, v65
    v_and_b32 v119, s61, v65
    v_lshlrev_b32 v120, 16, v66
    v_and_b32 v121, s61, v66
    v_lshlrev_b32 v122, 16, v67
    v_and_b32 v123, s61, v67
    v_lshlrev_b32 v124, 16, v68
    v_and_b32 v125, s61, v68
    v_lshlrev_b32 v126, 16, v69
    v_and_b32 v127, s61, v69
    v_pk_mul_f32 v[96:97], v[96:97], v[112:113]
    v_pk_mul_f32 v[98:99], v[98:99], v[114:115]
    v_pk_mul_f32 v[100:101], v[100:101], v[116:117]
    v_pk_mul_f32 v[102:103], v[102:103], v[118:119]
    v_pk_mul_f32 v[104:105], v[104:105], v[120:121]
    v_pk_mul_f32 v[106:107], v[106:107], v[122:123]
    v_pk_mul_f32 v[108:109], v[108:109], v[124:125]
    v_pk_mul_f32 v[110:111], v[110:111], v[126:127]
    v_cvt_pk_bf16_f32 v112, v111, v110
    v_cvt_pk_bf16_f32 v113, v109, v108
    v_cvt_pk_bf16_f32 v114, v107, v106
    v_cvt_pk_bf16_f32 v115, v105, v104
    v_cvt_pk_bf16_f32 v116, v103, v102
    v_cvt_pk_bf16_f32 v117, v101, v100
    v_cvt_pk_bf16_f32 v118, v99, v98
    v_cvt_pk_bf16_f32 v119, v97, v96
    ds_write_b128 v2, v[112:115]
    ds_write_b128 v2, v[116:119] offset:16
    ds_read_b128 a[232:235], v4
    ds_read_b128 a[236:239], v4 offset:1152
    s_waitcnt lgkmcnt(0)
    buffer_store_dwordx4 a[232:235], v3, s[40:43], s98 offen sc1
    buffer_store_dwordx4 a[236:239], v3, s[40:43], s99 offen sc1
    buffer_load_dwordx2 v[18:19], v9, s[44:47], 0 offen sc1
    global_load_dword v44, v[12:13], off
    v_lshl_add_u64 v[12:13], v[12:13], 0, v[14:15]
    global_load_dword v45, v[12:13], off
    v_lshl_add_u64 v[12:13], v[12:13], 0, v[14:15]
    global_load_dword v46, v[12:13], off
    v_lshl_add_u64 v[12:13], v[12:13], 0, v[14:15]
    global_load_dword v47, v[12:13], off
    v_lshl_add_u64 v[12:13], v[12:13], 0, v[14:15]
    s_lshl_b32 s56, s58, 13
    s_add_u32 s56, s56, s59
    s_add_u32 m0, s59, 152576
    s_nop 0
    buffer_load_dwordx4 v10, s[20:23], s56 offen nt lds
    s_add_u32 s56, s56, 4096
    s_add_u32 m0, s59, 157184
    s_nop 0
    buffer_load_dwordx4 v10, s[20:23], s56 offen nt lds
    v_mov_b32 v4, 0
    v_mov_b32 v5, 0
    v_mov_b32 v6, 0
    v_mov_b32 v7, 0
    v_lshrrev_b32 v3, 5, v1
    v_mul_u32_u24 v3, 4608, v3
    v_and_b32 v2, 31, v1
    v_lshl_add_u32 v3, v2, 4, v3
    v_add_u32 v3, 152064, v3
    ds_write_b128 v3, v[4:7]
    s_waitcnt vmcnt(6)
    s_mov_b32 s56, 0
L_nl_nn_5:
    v_readfirstlane_b32 s55, v19
    v_readfirstlane_b32 s54, v18
    s_cmp_lg_u32 s55, 0
    s_cbranch_scc1 L_nok_nn_5
    s_add_u32 s56, s56, 1
    s_cmp_lt_u32 s56, 200000
    s_cbranch_scc0 L_nok_nn_5
    s_sleep 8
    buffer_load_dwordx2 v[18:19], v9, s[44:47], 0 offen sc1
    s_waitcnt vmcnt(0)
    s_branch L_nl_nn_5
L_nok_nn_5:

    s_barrier
    s_mov_b64 exec, 1
    buffer_store_dwordx2 v[18:19], v9, s[40:43], s74 offen sc1
    s_mov_b64 exec, -1
    s_lshl_b32 s56, s4, 12
    s_lshl_b32 s57, s69, 5
    s_mul_i32 s63, s3, 7
    s_add_u32 s57, s57, s63
    v_and_b32 v3, 7, v1
    s_add_u32 s56, s56, s59
    v_lshl_add_u32 v2, v3, 7, s56
    v_min_u32 v3, 6, v3
    v_cmp_gt_u32 vcc, 32, v1
    v_add_lshl_u32 v3, v3, s57, 7
    s_nop 0
    v_cndmask_b32 v8, v3, v2, vcc
    buffer_load_dwordx2 v[6:7], v8, s[40:43], 0 offen sc1
    s_waitcnt vmcnt(0)
    v_cmp_ne_u64 vcc, s[54:55], v[6:7]
    s_mov_b32 s56, 0
    s_cmp_eq_u64 vcc, 0
    s_cbranch_scc1 L_ok_pl_6
L_re_pl_6:
    s_sleep 24
    buffer_load_dwordx2 v[6:7], v8, s[40:43], 0 offen sc1
    s_waitcnt vmcnt(0)
    v_cmp_ne_u64 vcc, s[54:55], v[6:7]
    s_add_u32 s56, s56, 1
    s_cmp_eq_u64 vcc, 0
    s_cbranch_scc1 L_ok_pl_6
    s_cmp_lt_u32 s56, 200000
    s_cbranch_scc1 L_re_pl_6
L_ok_pl_6:
    s_barrier
    s_lshl_b32 s56, s58, 13
    s_lshl_b32 s57, s3, 11
    s_add_u32 s56, s56, s57
    s_add_u32 s63, s56, 1048576
    buffer_load_dwordx4 v[20:23], v10, s[40:43], s63 offen sc1
    buffer_load_dword v24, v10, s[40:43], s63 offen offset:16 sc1
    buffer_load_dwordx4 v[28:31], v10, s[40:43], s63 offen offset:1024 sc1
    buffer_load_dword v25, v10, s[40:43], s63 offen offset:1040 sc1
    s_mul_i32 s71, s69, 56
    s_mul_i32 s56, s3, 14
    s_add_u32 s71, s71, s56
    s_lshl_b32 s71, s71, 12
    s_add_u32 s100, s71, 8388608
    s_mul_i32 s56, s65, 8320
    s_lshl_b32 s57, s64, 11
    s_add_u32 s57, s57, s56
    s_add_u32 s57, s57, 101376
    v_add_u32 v2, s57, v10
    v_bfe_u32 v3, v1, 4, 1
    v_mul_u32_u24 v3, 4160, v3
    v_and_b32 v4, 15, v1
    v_lshl_add_u32 v3, v4, 2, v3
    s_add_u32 s57, s56, 105472
    v_add_u32 v3, s57, v3
    v_and_b32 v6, 127, v0
    v_cmp_eq_u32 vcc, 127, v6
    ds_write_b32 v3, v9
    s_waitcnt vmcnt(0)
    ds_write_b128 v2, v[20:23]
    ds_write_b128 v2, v[28:31] offset:1024
    v_cndmask_b32 v25, v25, v9, vcc
    v_alignbit_b32 v4, v21, v20, 16
    v_alignbit_b32 v5, v22, v21, 16
    v_alignbit_b32 v6, v23, v22, 16
    v_alignbit_b32 v7, v24, v23, 16
    ds_write_b128 v2, v[4:7] offset:4160
    v_alignbit_b32 v20, v29, v28, 16
    v_alignbit_b32 v21, v30, v29, 16
    v_alignbit_b32 v22, v31, v30, 16
    v_alignbit_b32 v23, v25, v31, 16
    ds_write_b128 v2, v[20:23] offset:5184
    v_and_b32 v4, 15, v1
    v_and_b32 v7, 1, v1
    v_xor_b32 v7, 1, v7
    v_mul_u32_u24 v7, 4160, v7
    v_sub_u32 v5, 15, v4
    v_lshrrev_b32 v5, 1, v5
    v_lshl_add_u32 v7, v5, 2, v7
    v_lshrrev_b32 v5, 4, v1
    v_lshl_add_u32 v7, v5, 4, v7
    s_mul_i32 s56, s65, 8320
    s_lshl_b32 s57, s64, 8
    s_add_u32 s56, s57, s56
    s_add_u32 s56, s56, 101376
    v_add_u32 v24, s56, v7
    v_add_u32 v25, 1024, v24
    v_add_u32 v26, 2048, v24
    v_add_u32 v27, 3072, v24
    v_lshlrev_b32 v7, 5, v4
    v_lshl_add_u32 v7, v5, 4, v7
    s_mul_i32 s56, s65, 4608
    s_add_u32 s56, s56, s57
    s_add_u32 s56, s56, 152096
    v_add_u32 v28, s56, v7
    s_waitcnt lgkmcnt(0)
    s_barrier
    s_add_u32 s71, s100, 0
    buffer_load_dwordx4 a[0:3], v10, s[40:43], s71 offen offset:0 sc1
    buffer_load_dwordx4 a[4:7], v10, s[40:43], s71 offen offset:1024 sc1
    buffer_load_dwordx4 a[8:11], v10, s[40:43], s71 offen offset:2048 sc1
    buffer_load_dwordx4 a[12:15], v10, s[40:43], s71 offen offset:3072 sc1
    s_add_u32 s71, s100, 4096
    buffer_load_dwordx4 a[16:19], v10, s[40:43], s71 offen offset:0 sc1
    buffer_load_dwordx4 a[20:23], v10, s[40:43], s71 offen offset:1024 sc1
    buffer_load_dwordx4 a[24:27], v10, s[40:43], s71 offen offset:2048 sc1
    buffer_load_dwordx4 a[28:31], v10, s[40:43], s71 offen offset:3072 sc1
    s_add_u32 s71, s100, 8192
    buffer_load_dwordx4 a[32:35], v10, s[40:43], s71 offen offset:0 sc1
    buffer_load_dwordx4 a[36:39], v10, s[40:43], s71 offen offset:1024 sc1
    buffer_load_dwordx4 a[40:43], v10, s[40:43], s71 offen offset:2048 sc1
    buffer_load_dwordx4 a[44:47], v10, s[40:43], s71 offen offset:3072 sc1
    s_add_u32 s71, s100, 12288
    buffer_load_dwordx4 a[48:51], v10, s[40:43], s71 offen offset:0 sc1
    buffer_load_dwordx4 a[52:55], v10, s[40:43], s71 offen offset:1024 sc1
    buffer_load_dwordx4 a[56:59], v10, s[40:43], s71 offen offset:2048 sc1
    buffer_load_dwordx4 a[60:63], v10, s[40:43], s71 offen offset:3072 sc1
    s_add_u32 s71, s100, 16384
    buffer_load_dwordx4 a[64:67], v10, s[40:43], s71 offen offset:0 sc1
    buffer_load_dwordx4 a[68:71], v10, s[40:43], s71 offen offset:1024 sc1
    buffer_load_dwordx4 a[72:75], v10, s[40:43], s71 offen offset:2048 sc1
    buffer_load_dwordx4 a[76:79], v10, s[40:43], s71 offen offset:3072 sc1
    s_add_u32 s71, s100, 20480
    buffer_load_dwordx4 a[80:83], v10, s[40:43], s71 offen offset:0 sc1
    buffer_load_dwordx4 a[84:87], v10, s[40:43], s71 offen offset:1024 sc1
    buffer_load_dwordx4 a[88:91], v10, s[40:43], s71 offen offset:2048 sc1
    buffer_load_dwordx4 a[92:95], v10, s[40:43], s71 offen offset:3072 sc1
    s_add_u32 s71, s100, 24576
    buffer_load_dwordx4 a[96:99], v10, s[40:43], s71 offen offset:0 sc1
    buffer_load_dwordx4 a[100:103], v10, s[40:43], s71 offen offset:1024 sc1
    buffer_load_dwordx4 a[104:107], v10, s[40:43], s71 offen offset:2048 sc1
    buffer_load_dwordx4 a[108:111], v10, s[40:43], s71 offen offset:3072 sc1
    s_add_u32 s71, s100, 28672
    buffer_load_dwordx4 a[112:115], v10, s[40:43], s71 offen offset:0 sc1
    ds_read2_b32 v[32:33], v27 offset0:128 offset1:129
    ds_read2_b32 v[34:35], v27 offset0:130 offset1:131
    ds_read_b128 v[36:39], v28 offset:0
    ds_read2_b32 v[40:41], v27 offset0:0 offset1:1
    ds_read2_b32 v[42:43], v27 offset0:2 offset1:3
    ds_read_b128 v[44:47], v28 offset:512
    ds_read2_b32 v[48:49], v26 offset0:128 offset1:129
    ds_read2_b32 v[50:51], v26 offset0:130 offset1:131
    ds_read_b128 v[52:55], v28 offset:1024
    ds_read2_b32 v[56:57], v26 offset0:0 offset1:1
    ds_read2_b32 v[58:59], v26 offset0:2 offset1:3
    ds_read_b128 v[60:63], v28 offset:1536
    ds_read2_b32 v[64:65], v25 offset0:128 offset1:129
    ds_read2_b32 v[66:67], v25 offset0:130 offset1:131
    ds_read_b128 v[68:71], v28 offset:2048
    ds_read2_b32 v[72:73], v25 offset0:0 offset1:1
    ds_read2_b32 v[74:75], v25 offset0:2 offset1:3
    ds_read_b128 v[76:79], v28 offset:2560
    s_mov_b32 s72, 268435456
    s_mov_b32 s73, 268435456
    s_mov_b32 s68, 268435456
    s_branch L_conv
L_code_end:

.section .rodata,"a"
.p2align 6
.amdhsa_kernel gated_mix__ssm_conv_h3__glu_gated_bilinear__prompt_kernel
  .amdhsa_next_free_vgpr 512
  .amdhsa_next_free_sgpr 102
  .amdhsa_accum_offset 256
  .amdhsa_group_segment_fixed_size 0
  .amdhsa_kernarg_size 112
  .amdhsa_user_sgpr_count 2
  .amdhsa_user_sgpr_kernarg_segment_ptr 1
  .amdhsa_system_sgpr_workgroup_id_x 1
.end_amdhsa_kernel
```
